```python
import torch

def _softmax(x, axis=-1):
    return torch.softmax(x, dim=axis)
def _gelu(x):
    return torch.nn.functional.gelu(x, approximate="tanh")
def _silu(x):
    return torch.nn.functional.silu(x)
def _sigmoid(x):
    return torch.sigmoid(x)
def _layernorm(x, axis=-1, eps=1e-5):
    m = x.mean(dim=axis, keepdim=True)
    v = x.var(dim=axis, keepdim=True, unbiased=False)
    return (x - m) / torch.sqrt(v + eps)
def _scatter_add(tgt, idx, src, axis=0):
    return tgt.clone().index_add_(axis, idx, src)
def _segment_sum(src, seg, n):
    out = torch.zeros((n,) + src.shape[1:], dtype=src.dtype)
    return out.index_add_(0, seg, src)
def _pad(x, pw):
    flat = tuple(v for pair in reversed(pw) for v in pair)
    return torch.nn.functional.pad(x, flat)

kernel_name = 'parallel_sum__softmax_full_mha__mixer_s_mlp__prompt'

def setup_inputs():

    _w = (lambda a: (lambda t: t.to(torch.bfloat16) if t.is_floating_point() else t)(torch.as_tensor(a)))
    def _A_setup():
        B, S, D = 1, 2048, 512
        return {
            "x": _w((lambda *s: torch.randn(*s, dtype=torch.bfloat16) * 0.05)(B, S, D)),
            "wqkv": _w((lambda *s: torch.randn(*s, dtype=torch.bfloat16) * 0.1)(D, 3 * D)),
            "wo": _w((lambda *s: torch.randn(*s, dtype=torch.bfloat16) * 0.05)(D, D)),
        }
    _A_in = _A_setup()

    def _B_setup():
        B, S, D, F = 1, 2048, 512, 1376
        return {
            "x":  _w((lambda *s: torch.randn(*s, dtype=torch.bfloat16) * 0.05)(B, S, D)),
            "w1": _w((lambda *s: torch.randn(*s, dtype=torch.bfloat16) * 3.2)(D, D) * (D ** -0.5)),
            "w2": _w((lambda *s: torch.randn(*s, dtype=torch.bfloat16) * 3.2)(D, D) * (D ** -0.5)),
            "w3": _w((lambda *s: torch.randn(*s, dtype=torch.bfloat16) * 3.2)(D, F) * (D ** -0.5)),
            "w4": _w((lambda *s: torch.randn(*s, dtype=torch.bfloat16) * 3.2)(F, D) * (F ** -0.5)),
        }
    _B_in = _B_setup()

    return {
        "A_x": _A_in["x"],
        "A_wqkv": _A_in["wqkv"],
        "A_wo": _A_in["wo"],
        "B_x": _B_in["x"],
        "B_w1": _B_in["w1"],
        "B_w2": _B_in["w2"],
        "B_w3": _B_in["w3"],
        "B_w4": _B_in["w4"],
    }

def reference(A_x, A_wqkv, A_wo, B_x, B_w1, B_w2, B_w3, B_w4):
    def _A_ref(x, wqkv, wo):
        B, S, D = x.shape
        H = 32; Dh = D // H
        qkv = (lambda x, *d: x.permute(*d))((x @ wqkv).reshape(B, S, 3, H, Dh), 2, 0, 3, 1, 4)
        q, k, v = qkv[0], qkv[1], qkv[2]
        scale = Dh ** -0.5
        scores = torch.einsum("bhqd,bhkd->bhqk", q, k) * scale
        p = _softmax(scores, axis=-1)
        o = torch.einsum("bhqk,bhkd->bhqd", p, v)
        return (lambda x, *d: x.permute(*d))(o, 0, 2, 1, 3).reshape(B, S, D) @ wo

    def _B_ref(x, w1, w2, w3, w4):
        B, S, D = x.shape
        h = _gelu(_layernorm(x, axis=-1) @ w1)
        c = D // 4
        g0 = _pad(h[:, :, 0*c:1*c], ((0, 0), (1, 0), (0, 0)))[:, :S, :]
        g1 = _pad(h[:, :, 1*c:2*c], ((0, 0), (0, 1), (0, 0)))[:, 1:, :]
        g2 = _pad(h[:, :, 2*c:3*c], ((0, 0), (2, 0), (0, 0)))[:, :S, :]
        g3 = _pad(h[:, :, 3*c:   ], ((0, 0), (0, 2), (0, 0)))[:, 2:, :]
        hs = torch.concatenate([g0, g1, g2, g3], axis=-1) @ w2
        x1 = x + hs
        h2 = _gelu(_layernorm(x1, axis=-1) @ w3) @ w4
        return x1 + h2

    x = A_x
    xn = _layernorm(x, axis=-1)
    return x + _A_ref(xn, A_wqkv, A_wo) + _B_ref(xn, B_w1, B_w2, B_w3, B_w4)
```

```asm
; @launch kernel=k1_kernel grid=(256,1,1) block=(512,1,1) lds=151040
; @launch kernel=k2_kernel grid=(256,1,1) block=(768,1,1) lds=162304
.amdgcn_target "amdgcn-amd-amdhsa--gfx950"
.text
.globl k1_kernel
.p2align 8
.type k1_kernel,@function
k1_kernel:
    s_cmp_ge_u32 s2, 256
    s_cbranch_scc1 L_k1_exit
    s_load_dwordx4 s[4:7], s[0:1], 0
    s_load_dwordx4 s[8:11], s[0:1], 16
    s_load_dwordx4 s[12:15], s[0:1], 32
    s_load_dwordx4 s[16:19], s[0:1], 48
    s_load_dwordx2 s[20:21], s[0:1], 80
    v_lshrrev_b32 v1, 6, v0
    s_and_b32 s54, s2, 7
    v_readfirstlane_b32 s42, v1
    v_and_b32 v1, 63, v0
    s_lshr_b32 s55, s2, 3
    s_lshr_b32 s40, s54, 1
    s_lshl_b32 s40, s40, 2
    s_and_b32 s56, s55, 3
    s_add_u32 s40, s40, s56
    s_and_b32 s41, s54, 1
    s_lshl_b32 s41, s41, 3
    s_lshr_b32 s56, s55, 2
    s_add_u32 s41, s41, s56
    s_and_b32 s45, s42, 3
    s_cmp_lt_u32 s42, 4
    s_cbranch_scc1 L_k1_compute
    s_lshl_b32 s54, s40, 7
    s_lshl_b32 s55, s45, 5
    s_add_u32 s54, s54, s55
    v_lshrrev_b32 v56, 3, v1
    v_add_u32 v56, s54, v56
    v_lshlrev_b32 v56, 10, v56
    v_lshrrev_b32 v57, 4, v1
    v_and_b32 v58, 7, v1
    v_xor_b32 v59, v58, v57
    v_xor_b32 v60, 4, v59
    v_lshl_add_u32 v2, v59, 4, v56
    v_lshl_add_u32 v3, v60, 4, v56
    v_add_u32 v4, 14336, v2
    v_add_u32 v5, 21504, v3
    v_add_u32 v3, 7168, v3
    s_lshr_b32 s46, s45, 1
    s_lshl_b32 s44, s41, 1
    s_sub_u32 s44, s44, 8
    s_add_u32 s44, s44, s46
    s_cmp_lt_u32 s41, 8
    s_cselect_b32 s44, s41, s44
    s_cselect_b32 s54, s46, 0
    s_mov_b32 s30, 1572864
    s_mov_b32 s43, 3072
    s_cmp_eq_u32 s54, 1
    s_cselect_b32 s30, 524288, s30
    s_cselect_b32 s43, 1024, s43
    s_waitcnt lgkmcnt(0)
    s_cselect_b32 s28, s12, s6
    s_cselect_b32 s29, s13, s7
    s_and_b32 s29, s29, 0xffff
    s_mov_b32 s31, 0x00020000
    s_mov_b32 s24, s4
    s_and_b32 s25, s5, 0xffff
    s_mov_b32 s26, 2097152
    s_mov_b32 s27, 0x00020000
    s_lshl_b32 s44, s44, 7
    s_lshl_b32 s53, s43, 6
    v_lshrrev_b32 v58, 3, v1
    v_mul_lo_u32 v58, v58, s43
    v_and_b32 v59, 7, v1
    v_bfe_u32 v60, v1, 4, 1
    v_lshlrev_b32 v60, 2, v60
    v_xor_b32 v59, v59, v60
    v_lshl_add_u32 v58, v59, 4, v58
    v_add_u32 v6, s44, v58
    s_and_b32 s54, s45, 1
    s_lshl_b32 s54, s54, 5
    s_mul_i32 s48, s54, s43
    s_lshl_b32 s54, s43, 3
    s_sub_u32 s54, s54, 1024
    s_add_u32 s49, s48, s54
    s_add_u32 s50, s49, s54
    s_add_u32 s51, s50, s54
    s_mov_b32 s52, 0
    s_lshl_b32 s47, s45, 12
    s_add_u32 m0, s47, 0
    s_nop 0
    buffer_load_dwordx4 v2, s[24:27], s52 offen offset:0 lds
    buffer_load_dwordx4 v3, s[24:27], s52 offen offset:1024 lds
    buffer_load_dwordx4 v4, s[24:27], s52 offen offset:2048 lds
    buffer_load_dwordx4 v5, s[24:27], s52 offen offset:3072 lds
    s_add_u32 m0, s47, 65536
    s_add_u32 s52, s52, 128
    buffer_load_dwordx4 v6, s[28:31], s48 offen offset:0 lds
    buffer_load_dwordx4 v6, s[28:31], s49 offen offset:1024 lds
    buffer_load_dwordx4 v6, s[28:31], s50 offen offset:2048 lds
    buffer_load_dwordx4 v6, s[28:31], s51 offen offset:3072 lds
    s_add_u32 s48, s48, s53
    s_add_u32 s49, s49, s53
    s_add_u32 s50, s50, s53
    s_add_u32 s51, s51, s53
    s_add_u32 m0, s47, 16384
    s_nop 0
    buffer_load_dwordx4 v2, s[24:27], s52 offen offset:0 lds
    buffer_load_dwordx4 v3, s[24:27], s52 offen offset:1024 lds
    buffer_load_dwordx4 v4, s[24:27], s52 offen offset:2048 lds
    buffer_load_dwordx4 v5, s[24:27], s52 offen offset:3072 lds
    s_add_u32 m0, s47, 81920
    s_add_u32 s52, s52, 128
    buffer_load_dwordx4 v6, s[28:31], s48 offen offset:0 lds
    buffer_load_dwordx4 v6, s[28:31], s49 offen offset:1024 lds
    buffer_load_dwordx4 v6, s[28:31], s50 offen offset:2048 lds
    buffer_load_dwordx4 v6, s[28:31], s51 offen offset:3072 lds
    s_add_u32 s48, s48, s53
    s_add_u32 s49, s49, s53
    s_add_u32 s50, s50, s53
    s_add_u32 s51, s51, s53
    s_waitcnt vmcnt(8)
    s_barrier
    s_add_u32 m0, s47, 32768
    s_nop 0
    buffer_load_dwordx4 v2, s[24:27], s52 offen offset:0 lds
    buffer_load_dwordx4 v3, s[24:27], s52 offen offset:1024 lds
    buffer_load_dwordx4 v4, s[24:27], s52 offen offset:2048 lds
    buffer_load_dwordx4 v5, s[24:27], s52 offen offset:3072 lds
    s_add_u32 m0, s47, 98304
    s_add_u32 s52, s52, 128
    buffer_load_dwordx4 v6, s[28:31], s48 offen offset:0 lds
    buffer_load_dwordx4 v6, s[28:31], s49 offen offset:1024 lds
    buffer_load_dwordx4 v6, s[28:31], s50 offen offset:2048 lds
    buffer_load_dwordx4 v6, s[28:31], s51 offen offset:3072 lds
    s_add_u32 s48, s48, s53
    s_add_u32 s49, s49, s53
    s_add_u32 s50, s50, s53
    s_add_u32 s51, s51, s53
    s_add_u32 m0, s47, 49152
    s_nop 0
    buffer_load_dwordx4 v2, s[24:27], s52 offen offset:0 lds
    buffer_load_dwordx4 v3, s[24:27], s52 offen offset:1024 lds
    buffer_load_dwordx4 v4, s[24:27], s52 offen offset:2048 lds
    buffer_load_dwordx4 v5, s[24:27], s52 offen offset:3072 lds
    s_add_u32 m0, s47, 114688
    s_add_u32 s52, s52, 128
    buffer_load_dwordx4 v6, s[28:31], s48 offen offset:0 lds
    buffer_load_dwordx4 v6, s[28:31], s49 offen offset:1024 lds
    buffer_load_dwordx4 v6, s[28:31], s50 offen offset:2048 lds
    buffer_load_dwordx4 v6, s[28:31], s51 offen offset:3072 lds
    s_add_u32 s48, s48, s53
    s_add_u32 s49, s49, s53
    s_add_u32 s50, s50, s53
    s_add_u32 s51, s51, s53
    s_waitcnt vmcnt(16)
    s_barrier
    s_add_u32 m0, s47, 0
    s_nop 0
    buffer_load_dwordx4 v2, s[24:27], s52 offen offset:0 lds
    buffer_load_dwordx4 v3, s[24:27], s52 offen offset:1024 lds
    buffer_load_dwordx4 v4, s[24:27], s52 offen offset:2048 lds
    buffer_load_dwordx4 v5, s[24:27], s52 offen offset:3072 lds
    s_add_u32 m0, s47, 65536
    s_add_u32 s52, s52, 128
    buffer_load_dwordx4 v6, s[28:31], s48 offen offset:0 lds
    buffer_load_dwordx4 v6, s[28:31], s49 offen offset:1024 lds
    buffer_load_dwordx4 v6, s[28:31], s50 offen offset:2048 lds
    buffer_load_dwordx4 v6, s[28:31], s51 offen offset:3072 lds
    s_add_u32 s48, s48, s53
    s_add_u32 s49, s49, s53
    s_add_u32 s50, s50, s53
    s_add_u32 s51, s51, s53
    s_mov_b32 s62, 0
    s_mov_b32 s61, 32
    s_mov_b32 s63, 1024
    s_mov_b32 s59, 16
    s_mov_b32 s73, 0
    s_mov_b32 s38, 524288
    s_mov_b32 s56, s2
    s_cmp_lt_u32 s2, 32
    s_cbranch_scc1 L_k1_lw2
    s_cmp_lt_u32 s2, 64
    s_cbranch_scc1 L_k1_lwo
    s_cmp_lt_u32 s2, 150
    s_cbranch_scc1 L_k1_lw4
    s_cmp_lt_u32 s2, 246
    s_cbranch_scc1 L_k1_lw3
    s_mov_b32 s38, 0
    s_mov_b32 s59, 0
    s_mov_b32 s56, 0
L_k1_lw2:
    s_mov_b32 s36, s14
    s_mov_b32 s37, s15
    s_mov_b32 s60, 18874368
    s_branch L_k1_lgo
L_k1_lwo:
    s_mov_b32 s36, s8
    s_mov_b32 s37, s9
    s_mov_b32 s60, 19398656
    s_sub_u32 s56, s2, 32
    s_mov_b32 s73, 1
    s_branch L_k1_lgo
L_k1_lw4:
    s_mov_b32 s36, s18
    s_mov_b32 s37, s19
    s_mov_b32 s38, 1409024
    s_sub_u32 s56, s2, 64
    s_mov_b32 s60, 21495808
    s_mov_b32 s61, 86
    s_branch L_k1_lgo
L_k1_lw3:
    s_mov_b32 s36, s16
    s_mov_b32 s37, s17
    s_mov_b32 s38, 1409024
    s_sub_u32 s56, s2, 150
    s_lshr_b32 s62, s56, 5
    s_and_b32 s56, s56, 31
    s_mov_b32 s60, 19922944
    s_mov_b32 s63, 2752
    s_cmp_eq_u32 s62, 2
    s_cselect_b32 s59, 11, 16
L_k1_lgo:
    s_and_b32 s37, s37, 0xffff
    s_mov_b32 s39, 0x00020000
    s_lshl_b32 s54, s56, 4
    s_lshl_b32 s55, s45, 2
    s_add_u32 s54, s54, s55
    s_mul_i32 s54, s54, s63
    s_lshl_b32 s55, s62, 10
    s_add_u32 s54, s54, s55
    s_mul_i32 s55, s45, 4352
    s_add_u32 s55, s55, 133632
    v_lshlrev_b32 v56, 4, v1
    s_add_u32 m0, s55, 0
    s_nop 0
    buffer_load_dwordx4 v56, s[36:39], s54 offen lds
    s_add_u32 s54, s54, s63
    s_add_u32 m0, s55, 1088
    s_nop 0
    buffer_load_dwordx4 v56, s[36:39], s54 offen lds
    s_add_u32 s54, s54, s63
    s_add_u32 m0, s55, 2176
    s_nop 0
    buffer_load_dwordx4 v56, s[36:39], s54 offen lds
    s_add_u32 s54, s54, s63
    s_add_u32 m0, s55, 3264
    s_nop 0
    buffer_load_dwordx4 v56, s[36:39], s54 offen lds
    s_add_u32 s54, s54, s63
    s_waitcnt vmcnt(20)
    s_barrier
    s_add_u32 m0, s47, 16384
    s_nop 0
    buffer_load_dwordx4 v2, s[24:27], s52 offen offset:0 lds
    buffer_load_dwordx4 v3, s[24:27], s52 offen offset:1024 lds
    buffer_load_dwordx4 v4, s[24:27], s52 offen offset:2048 lds
    buffer_load_dwordx4 v5, s[24:27], s52 offen offset:3072 lds
    s_add_u32 m0, s47, 81920
    s_add_u32 s52, s52, 128
    buffer_load_dwordx4 v6, s[28:31], s48 offen offset:0 lds
    buffer_load_dwordx4 v6, s[28:31], s49 offen offset:1024 lds
    buffer_load_dwordx4 v6, s[28:31], s50 offen offset:2048 lds
    buffer_load_dwordx4 v6, s[28:31], s51 offen offset:3072 lds
    s_add_u32 s48, s48, s53
    s_add_u32 s49, s49, s53
    s_add_u32 s50, s50, s53
    s_add_u32 s51, s51, s53
    s_waitcnt vmcnt(20)
    s_barrier
    s_add_u32 m0, s47, 32768
    s_nop 0
    buffer_load_dwordx4 v2, s[24:27], s52 offen offset:0 lds
    buffer_load_dwordx4 v3, s[24:27], s52 offen offset:1024 lds
    buffer_load_dwordx4 v4, s[24:27], s52 offen offset:2048 lds
    buffer_load_dwordx4 v5, s[24:27], s52 offen offset:3072 lds
    s_add_u32 m0, s47, 98304
    s_add_u32 s52, s52, 128
    buffer_load_dwordx4 v6, s[28:31], s48 offen offset:0 lds
    buffer_load_dwordx4 v6, s[28:31], s49 offen offset:1024 lds
    buffer_load_dwordx4 v6, s[28:31], s50 offen offset:2048 lds
    buffer_load_dwordx4 v6, s[28:31], s51 offen offset:3072 lds
    s_add_u32 s48, s48, s53
    s_add_u32 s49, s49, s53
    s_add_u32 s50, s50, s53
    s_add_u32 s51, s51, s53
    s_waitcnt vmcnt(20)
    s_barrier
    s_add_u32 m0, s47, 49152
    s_nop 0
    buffer_load_dwordx4 v2, s[24:27], s52 offen offset:0 lds
    buffer_load_dwordx4 v3, s[24:27], s52 offen offset:1024 lds
    buffer_load_dwordx4 v4, s[24:27], s52 offen offset:2048 lds
    buffer_load_dwordx4 v5, s[24:27], s52 offen offset:3072 lds
    s_add_u32 m0, s47, 114688
    s_add_u32 s52, s52, 128
    buffer_load_dwordx4 v6, s[28:31], s48 offen offset:0 lds
    buffer_load_dwordx4 v6, s[28:31], s49 offen offset:1024 lds
    buffer_load_dwordx4 v6, s[28:31], s50 offen offset:2048 lds
    buffer_load_dwordx4 v6, s[28:31], s51 offen offset:3072 lds
    s_add_u32 s48, s48, s53
    s_add_u32 s49, s49, s53
    s_add_u32 s50, s50, s53
    s_add_u32 s51, s51, s53
L_k1_stat:
    v_and_b32 v56, 31, v1
    v_lshrrev_b32 v57, 5, v1
    s_lshl_b32 s54, s45, 5
    v_add_u32 v56, s54, v56
    v_lshlrev_b32 v56, 7, v56
    v_bfe_u32 v58, v1, 1, 3
    v_xor_b32 v58, v57, v58
    v_xor_b32 v59, 0, v58
    v_lshl_add_u32 v8, v59, 4, v56
    v_xor_b32 v59, 2, v58
    v_lshl_add_u32 v9, v59, 4, v56
    v_xor_b32 v59, 4, v58
    v_lshl_add_u32 v10, v59, 4, v56
    v_xor_b32 v59, 6, v58
    v_lshl_add_u32 v11, v59, 4, v56
    v_mov_b32 v12, 0
    v_mov_b32 v13, 0
    v_mov_b32 v14, 0
    v_mov_b32 v15, 0
    s_mov_b32 s72, 0xffff0000
    s_mov_b32 s71, 0xffff
    s_waitcnt lgkmcnt(0)
    s_mov_b32 s32, s20
    s_and_b32 s33, s21, 0xffff
    s_mov_b32 s34, 41943040
    s_mov_b32 s35, 0x00020000
    s_getpc_b64 s[66:67]
L_k1_pc:
    s_sub_u32 s66, s66, L_k1_pc-k1_kernel
    s_subb_u32 s67, s67, 0
    s_lshl_b32 s54, s45, 13
    v_lshlrev_b32 v58, 7, v1
    v_add_u32 v58, s54, v58
    v_mov_b32 v59, L_code_end-k1_kernel-4
    v_min_u32 v58, v58, v59
    v_mov_b32 v59, s67
    v_add_co_u32 v58, vcc, s66, v58
    v_addc_co_u32 v59, vcc, 0, v59, vcc
    global_load_dword v92, v[58:59], off
    s_cmp_ge_u32 s2, 64
    s_cbranch_scc1 L_k1_noflag
    s_cmp_lg_u32 s45, 0
    s_cbranch_scc1 L_k1_noflag
    s_lshl_b32 s54, s2, 8
    s_add_u32 s54, s54, 29360128
    v_lshlrev_b32 v58, 2, v1
    buffer_store_dword v12, v58, s[32:35], s54 offen
L_k1_noflag:
    s_mov_b32 s62, 0
    s_mov_b32 s61, 32
    s_mov_b32 s63, 1024
    s_mov_b32 s59, 16
    s_mov_b32 s73, 0
    s_mov_b32 s38, 524288
    s_mov_b32 s56, s2
    s_cmp_lt_u32 s2, 32
    s_cbranch_scc1 L_k1_sw2
    s_cmp_lt_u32 s2, 64
    s_cbranch_scc1 L_k1_swo
    s_cmp_lt_u32 s2, 150
    s_cbranch_scc1 L_k1_sw4
    s_cmp_lt_u32 s2, 246
    s_cbranch_scc1 L_k1_sw3
    s_mov_b32 s38, 0
    s_mov_b32 s59, 0
    s_mov_b32 s56, 0
L_k1_sw2:
    s_mov_b32 s36, s14
    s_mov_b32 s37, s15
    s_mov_b32 s60, 18874368
    s_branch L_k1_sgo
L_k1_swo:
    s_mov_b32 s36, s8
    s_mov_b32 s37, s9
    s_mov_b32 s60, 19398656
    s_sub_u32 s56, s2, 32
    s_mov_b32 s73, 1
    s_branch L_k1_sgo
L_k1_sw4:
    s_mov_b32 s36, s18
    s_mov_b32 s37, s19
    s_mov_b32 s38, 1409024
    s_sub_u32 s56, s2, 64
    s_mov_b32 s60, 21495808
    s_mov_b32 s61, 86
    s_branch L_k1_sgo
L_k1_sw3:
    s_mov_b32 s36, s16
    s_mov_b32 s37, s17
    s_mov_b32 s38, 1409024
    s_sub_u32 s56, s2, 150
    s_lshr_b32 s62, s56, 5
    s_and_b32 s56, s56, 31
    s_mov_b32 s60, 19922944
    s_mov_b32 s63, 2752
    s_cmp_eq_u32 s62, 2
    s_cselect_b32 s59, 11, 16
L_k1_sgo:
    s_add_u32 s54, s73, 2
    v_lshlrev_b32 v56, s54, v57
    v_bfe_u32 v58, v1, 2, 2
    v_add_u32 v56, v56, v58
    v_mul_u32_u24 v56, 1088, v56
    v_and_b32 v58, 3, v1
    v_lshl_add_u32 v56, v58, 3, v56
    v_bfe_u32 v58, v1, 4, 1
    v_lshl_add_u32 v56, v58, 5, v56
    s_lshl_b32 s54, s45, 8
    s_add_u32 s54, s54, 133632
    v_add_u32 v2, s54, v56
    s_mov_b32 s54, 8704
    s_cmp_eq_u32 s73, 1
    s_cselect_b32 s54, 4352, s54
    v_add_u32 v3, s54, v2
    v_lshlrev_b32 v4, 4, v1
    s_lshl_b32 s54, s62, 4
    s_lshl_b32 s55, s45, 2
    s_add_u32 s54, s54, s55
    s_mul_i32 s54, s54, s61
    s_add_u32 s54, s54, s56
    s_lshl_b32 s54, s54, 10
    s_add_u32 s60, s60, s54
    s_lshl_b32 s61, s61, 10
    s_sub_i32 s59, s59, s55
    v_bfe_u32 v58, v1, 4, 1
    v_xor_b32 v59, v58, v1
    v_and_b32 v59, 1, v59
    v_cmp_eq_u32 vcc, 0, v59
    v_mov_b32 v59, 0x3f803f80
    v_cmp_eq_u32 s[76:77], 1, v58
    v_cndmask_b32 v72, 0, v59, vcc
    v_mov_b32 v73, v72
    v_mov_b32 v74, v72
    v_mov_b32 v75, v72
    v_and_b32 v5, 31, v1
    v_lshlrev_b32 v5, 2, v5
    s_mul_i32 s64, s56, 1408*4
    s_lshl_b32 s54, s62, 11
    s_add_u32 s64, s64, s54
    s_lshl_b32 s54, s45, 9
    s_add_u32 s64, s64, s54
    s_add_u32 s64, s64, 29425664
    s_mov_b32 s70, 0
    v_mov_b32 v40, 0
    v_mov_b32 v41, 0
    v_mov_b32 v42, 0
    v_mov_b32 v43, 0
    v_mov_b32 v44, 0
    v_mov_b32 v45, 0
    v_mov_b32 v46, 0
    v_mov_b32 v47, 0
    v_mov_b32 v48, 0
    v_mov_b32 v49, 0
    v_mov_b32 v50, 0
    v_mov_b32 v51, 0
    v_mov_b32 v52, 0
    v_mov_b32 v53, 0
    v_mov_b32 v54, 0
    v_mov_b32 v55, 0
    s_waitcnt vmcnt(16)
    s_barrier
    s_waitcnt vmcnt(8)
    s_barrier
    s_waitcnt vmcnt(0)
    s_barrier
    ds_read_b64_tr_b16 v[56:57], v2 offset:0
    ds_read_b64_tr_b16 v[58:59], v3 offset:0
    ds_read_b64_tr_b16 v[60:61], v2 offset:64
    ds_read_b64_tr_b16 v[62:63], v3 offset:64
    ds_read_b64_tr_b16 v[64:65], v2 offset:128
    ds_read_b64_tr_b16 v[66:67], v3 offset:128
    ds_read_b64_tr_b16 v[68:69], v2 offset:192
    ds_read_b64_tr_b16 v[70:71], v3 offset:192
    s_waitcnt lgkmcnt(0)
    s_cmp_le_i32 s59, 0
    s_cbranch_scc1 L_k1_snoprep
    buffer_store_dwordx4 v[56:59], v4, s[32:35], s60 offen sc1
    s_add_u32 s60, s60, s61
    s_cmp_le_i32 s59, 1
    s_cbranch_scc1 L_k1_snoprep
    buffer_store_dwordx4 v[60:63], v4, s[32:35], s60 offen sc1
    s_add_u32 s60, s60, s61
    s_cmp_le_i32 s59, 2
    s_cbranch_scc1 L_k1_snoprep
    buffer_store_dwordx4 v[64:67], v4, s[32:35], s60 offen sc1
    s_add_u32 s60, s60, s61
    s_cmp_le_i32 s59, 3
    s_cbranch_scc1 L_k1_snoprep
    buffer_store_dwordx4 v[68:71], v4, s[32:35], s60 offen sc1
    s_add_u32 s60, s60, s61
L_k1_snoprep:
    s_cmp_lg_u32 s63, 2752
    s_cbranch_scc1 L_k1_snocs
    v_mfma_f32_16x16x32_bf16 v[76:79], v[72:75], v[56:59], 0
    v_mfma_f32_16x16x32_bf16 v[80:83], v[72:75], v[60:63], 0
    v_mfma_f32_16x16x32_bf16 v[84:87], v[72:75], v[64:67], 0
    v_mfma_f32_16x16x32_bf16 v[88:91], v[72:75], v[68:71], 0
    s_nop 7
    v_cndmask_b32 v76, v76, v77, s[76:77]
    v_cndmask_b32 v80, v80, v81, s[76:77]
    v_cndmask_b32 v84, v84, v85, s[76:77]
    v_cndmask_b32 v88, v88, v89, s[76:77]
    s_cmp_le_i32 s59, 0
    s_cbranch_scc1 L_k1_snocs
    buffer_store_dword v76, v5, s[32:35], s64 offen offset:0 sc1
    s_cmp_le_i32 s59, 1
    s_cbranch_scc1 L_k1_snocs
    buffer_store_dword v80, v5, s[32:35], s64 offen offset:128 sc1
    s_cmp_le_i32 s59, 2
    s_cbranch_scc1 L_k1_snocs
    buffer_store_dword v84, v5, s[32:35], s64 offen offset:256 sc1
    s_cmp_le_i32 s59, 3
    s_cbranch_scc1 L_k1_snocs
    buffer_store_dword v88, v5, s[32:35], s64 offen offset:384 sc1
L_k1_snocs:
    s_barrier
    s_endpgm
L_k1_compute:
    v_and_b32 v8, 31, v1
    v_lshrrev_b32 v9, 5, v1
    s_lshl_b32 s54, s45, 5
    v_add_u32 v10, s54, v8
    v_lshlrev_b32 v10, 7, v10
    v_bfe_u32 v11, v1, 1, 3
    v_xor_b32 v11, v9, v11
    v_xor_b32 v12, 0, v11
    v_lshl_add_u32 v2, v12, 4, v10
    v_xor_b32 v12, 2, v11
    v_lshl_add_u32 v3, v12, 4, v10
    v_xor_b32 v12, 4, v11
    v_lshl_add_u32 v4, v12, 4, v10
    v_xor_b32 v12, 6, v11
    v_lshl_add_u32 v5, v12, 4, v10
    v_bfe_u32 v10, v1, 2, 2
    v_lshl_add_u32 v10, v9, 3, v10
    v_lshlrev_b32 v10, 7, v10
    v_and_b32 v11, 3, v1
    v_lshl_add_u32 v10, v11, 3, v10
    v_bfe_u32 v11, v1, 3, 1
    v_lshl_add_u32 v10, v11, 6, v10
    v_bfe_u32 v11, v1, 4, 1
    v_lshl_add_u32 v10, v11, 5, v10
    v_add_u32 v6, 65536, v10
    v_xor_b32 v16, 64, v6
    v_xor_b32 v10, v11, v1
    v_and_b32 v10, 1, v10
    v_cmp_eq_u32 vcc, 0, v10
    v_mov_b32 v10, 0x3f803f80
    v_cmp_eq_u32 s[76:77], 1, v11
    v_cndmask_b32 v12, 0, v10, vcc
    v_mov_b32 v13, v12
    v_mov_b32 v14, v12
    v_mov_b32 v15, v12
    s_lshr_b32 s54, s45, 1
    s_lshl_b32 s54, s54, 13
    s_and_b32 s55, s45, 1
    s_lshl_b32 s55, s55, 6
    v_xor_b32 v7, s55, v6
    v_add_u32 v7, s54, v7
    s_mov_b32 s73, 0xffff
    s_mov_b32 s74, 0x10000
    s_waitcnt lgkmcnt(0)
    s_mov_b32 s32, s20
    s_and_b32 s33, s21, 0xffff
    s_mov_b32 s34, 41943040
    s_mov_b32 s35, 0x00020000
    v_mov_b32 v24, 0
    v_mov_b32 v25, 0
    v_mov_b32 v26, 0
    v_mov_b32 v27, 0
    v_mov_b32 v28, 0
    v_mov_b32 v29, 0
    v_mov_b32 v30, 0
    v_mov_b32 v31, 0
    v_mov_b32 v80, 0
    v_mov_b32 v81, 0
    v_mov_b32 v82, 0
    v_mov_b32 v83, 0
    v_mov_b32 v84, 0
    v_mov_b32 v85, 0
    v_mov_b32 v86, 0
    v_mov_b32 v87, 0
    v_mov_b32 v96, 0
    v_mov_b32 v97, 0
    v_mov_b32 v98, 0
    v_mov_b32 v99, 0
    v_mov_b32 v100, 0
    v_mov_b32 v101, 0
    v_mov_b32 v102, 0
    v_mov_b32 v103, 0
    v_mov_b32 v104, 0
    v_mov_b32 v105, 0
    v_mov_b32 v106, 0
    v_mov_b32 v107, 0
    v_mov_b32 v108, 0
    v_mov_b32 v109, 0
    v_mov_b32 v110, 0
    v_mov_b32 v111, 0
    v_mov_b32 v112, 0
    v_mov_b32 v113, 0
    v_mov_b32 v114, 0
    v_mov_b32 v115, 0
    v_mov_b32 v116, 0
    v_mov_b32 v117, 0
    v_mov_b32 v118, 0
    v_mov_b32 v119, 0
    v_mov_b32 v120, 0
    v_mov_b32 v121, 0
    v_mov_b32 v122, 0
    v_mov_b32 v123, 0
    v_mov_b32 v124, 0
    v_mov_b32 v125, 0
    v_mov_b32 v126, 0
    v_mov_b32 v127, 0
    v_mov_b32 v128, 0
    v_mov_b32 v129, 0
    v_mov_b32 v130, 0
    v_mov_b32 v131, 0
    v_mov_b32 v132, 0
    v_mov_b32 v133, 0
    v_mov_b32 v134, 0
    v_mov_b32 v135, 0
    v_mov_b32 v136, 0
    v_mov_b32 v137, 0
    v_mov_b32 v138, 0
    v_mov_b32 v139, 0
    v_mov_b32 v140, 0
    v_mov_b32 v141, 0
    v_mov_b32 v142, 0
    v_mov_b32 v143, 0
    v_mov_b32 v144, 0
    v_mov_b32 v145, 0
    v_mov_b32 v146, 0
    v_mov_b32 v147, 0
    v_mov_b32 v148, 0
    v_mov_b32 v149, 0
    v_mov_b32 v150, 0
    v_mov_b32 v151, 0
    v_mov_b32 v152, 0
    v_mov_b32 v153, 0
    v_mov_b32 v154, 0
    v_mov_b32 v155, 0
    v_mov_b32 v156, 0
    v_mov_b32 v157, 0
    v_mov_b32 v158, 0
    v_mov_b32 v159, 0
    s_barrier
    ds_read_b128 v[32:35], v2
    ds_read_b64_tr_b16 v[36:37], v6 offset:0
    ds_read_b64_tr_b16 v[38:39], v6 offset:512
    ds_read_b64_tr_b16 v[40:41], v16 offset:0
    ds_read_b64_tr_b16 v[42:43], v16 offset:512
    ds_read_b64_tr_b16 v[44:45], v6 offset:8192
    ds_read_b64_tr_b16 v[46:47], v6 offset:8704
    ds_read_b64_tr_b16 v[48:49], v16 offset:8192
    ds_read_b64_tr_b16 v[50:51], v16 offset:8704
    ds_read_b64_tr_b16 v[52:53], v7 offset:0
    ds_read_b64_tr_b16 v[54:55], v7 offset:512
    v_add_u32 v2, 16384, v2
    v_and_b32 v2, s73, v2
    s_mov_b32 s70, 8
L_k1_loop:
    s_waitcnt lgkmcnt(8)
    v_mfma_f32_32x32x16_bf16 v[96:111], v[36:39], v[32:35], v[96:111]
    ds_read_b128 v[56:59], v3
    ds_read_b64_tr_b16 v[60:61], v6 offset:2048
    ds_read_b64_tr_b16 v[62:63], v6 offset:2560
    ds_read_b64_tr_b16 v[64:65], v16 offset:2048
    s_waitcnt lgkmcnt(10)
    v_mfma_f32_32x32x16_bf16 v[112:127], v[40:43], v[32:35], v[112:127]
    ds_read_b64_tr_b16 v[66:67], v16 offset:2560
    ds_read_b64_tr_b16 v[68:69], v6 offset:10240
    ds_read_b64_tr_b16 v[70:71], v6 offset:10752
    ds_read_b64_tr_b16 v[72:73], v16 offset:10240
    s_waitcnt lgkmcnt(12)
    v_mfma_f32_32x32x16_bf16 v[128:143], v[44:47], v[32:35], v[128:143]
    ds_read_b64_tr_b16 v[74:75], v16 offset:10752
    ds_read_b64_tr_b16 v[76:77], v7 offset:2048
    ds_read_b64_tr_b16 v[78:79], v7 offset:2560
    s_waitcnt lgkmcnt(13)
    v_mfma_f32_32x32x16_bf16 v[144:159], v[48:51], v[32:35], v[144:159]
    v_add_u32 v3, 16384, v3
    v_and_b32 v3, s73, v3
    v_mfma_f32_16x16x32_bf16 v[28:31], v[12:15], v[32:35], v[28:31]
    v_mfma_f32_4x4x4_16b_bf16 v[80:83], v[32:33], v[32:33], v[80:83]
    v_mfma_f32_4x4x4_16b_bf16 v[84:87], v[34:35], v[34:35], v[84:87]
    s_waitcnt lgkmcnt(11)
    v_mfma_f32_16x16x32_bf16 v[24:27], v[12:15], v[52:55], v[24:27]
    s_waitcnt lgkmcnt(8)
    v_mfma_f32_32x32x16_bf16 v[96:111], v[60:63], v[56:59], v[96:111]
    ds_read_b128 v[32:35], v4
    ds_read_b64_tr_b16 v[36:37], v6 offset:4096
    ds_read_b64_tr_b16 v[38:39], v6 offset:4608
    ds_read_b64_tr_b16 v[40:41], v16 offset:4096
    s_waitcnt lgkmcnt(10)
    v_mfma_f32_32x32x16_bf16 v[112:127], v[64:67], v[56:59], v[112:127]
    ds_read_b64_tr_b16 v[42:43], v16 offset:4608
    ds_read_b64_tr_b16 v[44:45], v6 offset:12288
    ds_read_b64_tr_b16 v[46:47], v6 offset:12800
    ds_read_b64_tr_b16 v[48:49], v16 offset:12288
    s_waitcnt lgkmcnt(12)
    v_mfma_f32_32x32x16_bf16 v[128:143], v[68:71], v[56:59], v[128:143]
    ds_read_b64_tr_b16 v[50:51], v16 offset:12800
    ds_read_b64_tr_b16 v[52:53], v7 offset:4096
    ds_read_b64_tr_b16 v[54:55], v7 offset:4608
    s_waitcnt lgkmcnt(13)
    v_mfma_f32_32x32x16_bf16 v[144:159], v[72:75], v[56:59], v[144:159]
    v_add_u32 v4, 16384, v4
    v_and_b32 v4, s73, v4
    v_mfma_f32_16x16x32_bf16 v[28:31], v[12:15], v[56:59], v[28:31]
    v_mfma_f32_4x4x4_16b_bf16 v[80:83], v[56:57], v[56:57], v[80:83]
    v_mfma_f32_4x4x4_16b_bf16 v[84:87], v[58:59], v[58:59], v[84:87]
    s_waitcnt lgkmcnt(11)
    v_mfma_f32_16x16x32_bf16 v[24:27], v[12:15], v[76:79], v[24:27]
    s_waitcnt lgkmcnt(8)
    v_mfma_f32_32x32x16_bf16 v[96:111], v[36:39], v[32:35], v[96:111]
    ds_read_b128 v[56:59], v5
    ds_read_b64_tr_b16 v[60:61], v6 offset:6144
    ds_read_b64_tr_b16 v[62:63], v6 offset:6656
    ds_read_b64_tr_b16 v[64:65], v16 offset:6144
    s_waitcnt lgkmcnt(10)
    v_mfma_f32_32x32x16_bf16 v[112:127], v[40:43], v[32:35], v[112:127]
    ds_read_b64_tr_b16 v[66:67], v16 offset:6656
    ds_read_b64_tr_b16 v[68:69], v6 offset:14336
    ds_read_b64_tr_b16 v[70:71], v6 offset:14848
    ds_read_b64_tr_b16 v[72:73], v16 offset:14336
    s_waitcnt lgkmcnt(12)
    v_mfma_f32_32x32x16_bf16 v[128:143], v[44:47], v[32:35], v[128:143]
    ds_read_b64_tr_b16 v[74:75], v16 offset:14848
    ds_read_b64_tr_b16 v[76:77], v7 offset:6144
    ds_read_b64_tr_b16 v[78:79], v7 offset:6656
    s_waitcnt lgkmcnt(13)
    v_mfma_f32_32x32x16_bf16 v[144:159], v[48:51], v[32:35], v[144:159]
    v_add_u32 v5, 16384, v5
    v_and_b32 v5, s73, v5
    v_add_u32 v6, 16384, v6
    v_and_b32 v6, s73, v6
    v_or_b32 v6, s74, v6
    v_mfma_f32_16x16x32_bf16 v[28:31], v[12:15], v[32:35], v[28:31]
    v_mfma_f32_4x4x4_16b_bf16 v[80:83], v[32:33], v[32:33], v[80:83]
    v_mfma_f32_4x4x4_16b_bf16 v[84:87], v[34:35], v[34:35], v[84:87]
    s_waitcnt lgkmcnt(11)
    v_add_u32 v16, 16384, v16
    v_and_b32 v16, s73, v16
    v_or_b32 v16, s74, v16
    v_mfma_f32_16x16x32_bf16 v[24:27], v[12:15], v[52:55], v[24:27]
    v_add_u32 v7, 16384, v7
    v_and_b32 v7, s73, v7
    v_or_b32 v7, s74, v7
    s_waitcnt lgkmcnt(8)
    v_mfma_f32_32x32x16_bf16 v[96:111], v[60:63], v[56:59], v[96:111]
    s_sub_u32 s70, s70, 1
    s_waitcnt lgkmcnt(6)
    v_mfma_f32_32x32x16_bf16 v[112:127], v[64:67], v[56:59], v[112:127]
    s_waitcnt lgkmcnt(0)
    s_cmp_eq_u32 s70, 0
    s_cbranch_scc1 L_k1_nobar
    s_barrier
L_k1_nobar:
    ds_read_b128 v[32:35], v2
    ds_read_b64_tr_b16 v[36:37], v6 offset:0
    ds_read_b64_tr_b16 v[38:39], v6 offset:512
    v_mfma_f32_32x32x16_bf16 v[128:143], v[68:71], v[56:59], v[128:143]
    ds_read_b64_tr_b16 v[40:41], v16 offset:0
    ds_read_b64_tr_b16 v[42:43], v16 offset:512
    ds_read_b64_tr_b16 v[44:45], v6 offset:8192
    ds_read_b64_tr_b16 v[46:47], v6 offset:8704
    v_mfma_f32_32x32x16_bf16 v[144:159], v[72:75], v[56:59], v[144:159]
    ds_read_b64_tr_b16 v[48:49], v16 offset:8192
    ds_read_b64_tr_b16 v[50:51], v16 offset:8704
    ds_read_b64_tr_b16 v[52:53], v7 offset:0
    ds_read_b64_tr_b16 v[54:55], v7 offset:512
    v_mfma_f32_16x16x32_bf16 v[28:31], v[12:15], v[56:59], v[28:31]
    v_mfma_f32_4x4x4_16b_bf16 v[80:83], v[56:57], v[56:57], v[80:83]
    v_mfma_f32_4x4x4_16b_bf16 v[84:87], v[58:59], v[58:59], v[84:87]
    v_add_u32 v2, 16384, v2
    v_and_b32 v2, s73, v2
    v_mfma_f32_16x16x32_bf16 v[24:27], v[12:15], v[76:79], v[24:27]
    s_cmp_lg_u32 s70, 0
    s_cbranch_scc1 L_k1_loop
    s_lshl_b32 s54, s45, 7
    s_add_u32 s54, s54, 131072
    v_lshl_add_u32 v7, v8, 2, s54
    s_lshl_b32 s54, s45, 9
    s_add_u32 s54, s54, 131584
    v_lshl_add_u32 v6, v8, 2, s54
    s_lshl_b32 s58, s40, 2
    s_add_u32 s58, s58, s45
    s_nop 2
    v_cndmask_b32 v24, v24, v25, s[76:77]
    ds_write_b32 v7, v24
    v_cndmask_b32 v24, v28, v29, s[76:77]
    v_add_f32 v80, v80, v84
    v_add_f32 v81, v81, v85
    v_add_f32 v82, v82, v86
    v_add_f32 v83, v83, v87
    v_and_b32 v2, 1, v1
    v_cmp_eq_u32 vcc, 1, v2
    v_and_b32 v2, 2, v1
    v_cmp_eq_u32 s[66:67], 2, v2
    v_cndmask_b32 v80, v80, v81, vcc
    v_cndmask_b32 v82, v82, v83, vcc
    v_lshl_add_u32 v2, v1, 2, s54
    v_cndmask_b32 v80, v80, v82, s[66:67]
    ds_write_b32 v2, v80 offset:256
    v_lshlrev_b32 v20, 4, v1
    v_lshlrev_b32 v21, 5, v8
    v_lshl_add_u32 v21, v9, 4, v21
    s_lshr_b32 s57, s41, 1
    s_lshr_b32 s54, s57, 1
    s_add_u32 s54, s54, 1
    s_sub_u32 s55, 0, s54
    s_bitcmp1_b32 s57, 0
    s_cselect_b32 s54, s55, s54
    s_lshl_b32 s55, s58, 5
    s_add_u32 s55, s55, s54
    v_add_u32 v22, s55, v8
    v_cmp_gt_u32 vcc, 2048, v22
    v_and_b32 v22, 2047, v22
    v_lshrrev_b32 v23, 5, v22
    v_lshlrev_b32 v23, 15, v23
    v_and_b32 v22, 31, v22
    v_lshl_add_u32 v23, v22, 4, v23
    v_lshl_add_u32 v23, v9, 9, v23
    v_cndmask_b32 v22, 0, 1.0, vcc
    v_lshlrev_b32 v7, 4, v9
    v_add_u32 v7, 131072, v7
    s_waitcnt lgkmcnt(0)
    s_barrier
    ds_read_b32 v16, v6 offset:256
    ds_read_b32 v17, v6 offset:384
    ds_read_b128 v[32:35], v7 offset:0
    ds_read_b128 v[36:39], v7 offset:32
    ds_read_b128 v[40:43], v7 offset:64
    ds_read_b128 v[44:47], v7 offset:96
    ds_read_b128 v[48:51], v7 offset:128
    ds_read_b128 v[52:55], v7 offset:160
    ds_read_b128 v[56:59], v7 offset:192
    ds_read_b128 v[60:63], v7 offset:224
    ds_read_b128 v[64:67], v7 offset:256
    ds_read_b128 v[68:71], v7 offset:288
    ds_read_b128 v[72:75], v7 offset:320
    ds_read_b128 v[76:79], v7 offset:352
    ds_read_b128 v[80:83], v7 offset:384
    s_waitcnt lgkmcnt(13)
    ds_read_b128 v[84:87], v7 offset:416
    ds_read_b128 v[88:91], v7 offset:448
    ds_read_b128 v[92:95], v7 offset:480
    v_add_f32 v16, v16, v17
    v_mul_f32 v24, 0x3b000000, v24
    v_mul_f32 v16, 0x3b000000, v16
    v_fma_f32 v16, -v24, v24, v16
    v_max_f32 v16, 0, v16
    v_add_f32 v17, 0x3727c5ac, v16
    v_rsq_f32 v25, v17
    v_mov_b32 v19, 0x3727c5ac
    v_mul_f32 v18, v25, v25
    v_fma_f32 v18, v18, v16, v19
    v_rsq_f32 v18, v18
    v_mul_f32 v26, v24, v25
    v_sub_f32 v26, 0, v26
    v_mul_f32 v18, v18, v22
    s_cmp_lg_u32 s41, 0
    s_cbranch_scc1 L_k1_nostat
    s_lshl_b32 s54, s58, 8
    s_add_u32 s54, s54, 23068672
    v_lshlrev_b32 v19, 3, v8
    buffer_store_dwordx2 v[24:25], v19, s[32:35], s54 offen
L_k1_nostat:
    s_lshl_b32 s56, s41, 2
    s_sub_u32 s56, s56, 16
    s_lshl_b32 s54, s41, 1
    s_cmp_lt_u32 s41, 8
    s_cselect_b32 s56, s54, s56
    s_mov_b32 s60, 0x3eb8aa3b
    s_mov_b32 s62, 0xbdd2d3e8
    s_mov_b32 s63, 0xbdd2d3e8
    v_mov_b32 v16, 0xc0135761
    s_waitcnt lgkmcnt(0)
    s_add_u32 s55, s56, 0
    s_cmp_lt_u32 s55, 16
    s_cselect_b32 s54, s60, 1.0
    v_mul_f32 v28, s54, v25
    v_mul_f32 v30, s54, v26
    s_cmp_ge_u32 s55, 32
    s_cselect_b64 vcc, -1, 0
    s_lshl_b32 s55, s55, 7
    s_add_u32 s55, s55, s58
    s_lshl_b32 s55, s55, 10
    s_add_u32 s59, s55, 65536
    v_cndmask_b32 v27, v20, v21, vcc
    v_pk_mul_f32 v[32:33], v[32:33], v[30:31] op_sel_hi:[1,0]
    v_pk_mul_f32 v[34:35], v[34:35], v[30:31] op_sel_hi:[1,0]
    v_pk_mul_f32 v[36:37], v[36:37], v[30:31] op_sel_hi:[1,0]
    v_pk_mul_f32 v[38:39], v[38:39], v[30:31] op_sel_hi:[1,0]
    v_pk_mul_f32 v[40:41], v[40:41], v[30:31] op_sel_hi:[1,0]
    v_pk_mul_f32 v[42:43], v[42:43], v[30:31] op_sel_hi:[1,0]
    v_pk_mul_f32 v[44:45], v[44:45], v[30:31] op_sel_hi:[1,0]
    v_pk_mul_f32 v[46:47], v[46:47], v[30:31] op_sel_hi:[1,0]
    v_pk_fma_f32 v[96:97], v[96:97], v[28:29], v[32:33] op_sel_hi:[1,0,1]
    v_pk_fma_f32 v[98:99], v[98:99], v[28:29], v[34:35] op_sel_hi:[1,0,1]
    v_pk_fma_f32 v[100:101], v[100:101], v[28:29], v[36:37] op_sel_hi:[1,0,1]
    v_pk_fma_f32 v[102:103], v[102:103], v[28:29], v[38:39] op_sel_hi:[1,0,1]
    v_pk_fma_f32 v[104:105], v[104:105], v[28:29], v[40:41] op_sel_hi:[1,0,1]
    v_pk_fma_f32 v[106:107], v[106:107], v[28:29], v[42:43] op_sel_hi:[1,0,1]
    v_pk_fma_f32 v[108:109], v[108:109], v[28:29], v[44:45] op_sel_hi:[1,0,1]
    v_pk_fma_f32 v[110:111], v[110:111], v[28:29], v[46:47] op_sel_hi:[1,0,1]
    v_cvt_pk_bf16_f32 v160, v96, v97
    v_cvt_pk_bf16_f32 v161, v98, v99
    v_cvt_pk_bf16_f32 v162, v100, v101
    v_cvt_pk_bf16_f32 v163, v102, v103
    v_cvt_pk_bf16_f32 v164, v104, v105
    v_cvt_pk_bf16_f32 v165, v106, v107
    v_cvt_pk_bf16_f32 v166, v108, v109
    v_cvt_pk_bf16_f32 v167, v110, v111
    buffer_store_dwordx4 v[160:163], v27, s[32:35], s55 offen sc1
    buffer_store_dwordx4 v[164:167], v27, s[32:35], s59 offen sc1
    s_add_u32 s55, s56, 1
    s_cmp_lt_u32 s55, 16
    s_cselect_b32 s54, s60, 1.0
    v_mul_f32 v28, s54, v25
    v_mul_f32 v30, s54, v26
    s_cmp_ge_u32 s55, 32
    s_cselect_b64 vcc, -1, 0
    s_lshl_b32 s55, s55, 7
    s_add_u32 s55, s55, s58
    s_lshl_b32 s55, s55, 10
    s_add_u32 s59, s55, 65536
    v_cndmask_b32 v27, v20, v21, vcc
    v_pk_mul_f32 v[48:49], v[48:49], v[30:31] op_sel_hi:[1,0]
    v_pk_mul_f32 v[50:51], v[50:51], v[30:31] op_sel_hi:[1,0]
    v_pk_mul_f32 v[52:53], v[52:53], v[30:31] op_sel_hi:[1,0]
    v_pk_mul_f32 v[54:55], v[54:55], v[30:31] op_sel_hi:[1,0]
    v_pk_mul_f32 v[56:57], v[56:57], v[30:31] op_sel_hi:[1,0]
    v_pk_mul_f32 v[58:59], v[58:59], v[30:31] op_sel_hi:[1,0]
    v_pk_mul_f32 v[60:61], v[60:61], v[30:31] op_sel_hi:[1,0]
    v_pk_mul_f32 v[62:63], v[62:63], v[30:31] op_sel_hi:[1,0]
    v_pk_fma_f32 v[112:113], v[112:113], v[28:29], v[48:49] op_sel_hi:[1,0,1]
    v_pk_fma_f32 v[114:115], v[114:115], v[28:29], v[50:51] op_sel_hi:[1,0,1]
    v_pk_fma_f32 v[116:117], v[116:117], v[28:29], v[52:53] op_sel_hi:[1,0,1]
    v_pk_fma_f32 v[118:119], v[118:119], v[28:29], v[54:55] op_sel_hi:[1,0,1]
    v_pk_fma_f32 v[120:121], v[120:121], v[28:29], v[56:57] op_sel_hi:[1,0,1]
    v_pk_fma_f32 v[122:123], v[122:123], v[28:29], v[58:59] op_sel_hi:[1,0,1]
    v_pk_fma_f32 v[124:125], v[124:125], v[28:29], v[60:61] op_sel_hi:[1,0,1]
    v_pk_fma_f32 v[126:127], v[126:127], v[28:29], v[62:63] op_sel_hi:[1,0,1]
    v_cvt_pk_bf16_f32 v32, v112, v113
    v_cvt_pk_bf16_f32 v33, v114, v115
    v_cvt_pk_bf16_f32 v34, v116, v117
    v_cvt_pk_bf16_f32 v35, v118, v119
    v_cvt_pk_bf16_f32 v36, v120, v121
    v_cvt_pk_bf16_f32 v37, v122, v123
    v_cvt_pk_bf16_f32 v38, v124, v125
    v_cvt_pk_bf16_f32 v39, v126, v127
    buffer_store_dwordx4 v[32:35], v27, s[32:35], s55 offen sc1
    buffer_store_dwordx4 v[36:39], v27, s[32:35], s59 offen sc1
    s_cmp_lt_u32 s41, 8
    s_cbranch_scc1 L_k1_htiles
    s_add_u32 s55, s56, 2
    s_cmp_lt_u32 s55, 16
    s_cselect_b32 s54, s60, 1.0
    v_mul_f32 v28, s54, v25
    v_mul_f32 v30, s54, v26
    s_cmp_ge_u32 s55, 32
    s_cselect_b64 vcc, -1, 0
    s_lshl_b32 s55, s55, 7
    s_add_u32 s55, s55, s58
    s_lshl_b32 s55, s55, 10
    s_add_u32 s59, s55, 65536
    v_cndmask_b32 v27, v20, v21, vcc
    v_pk_mul_f32 v[64:65], v[64:65], v[30:31] op_sel_hi:[1,0]
    v_pk_mul_f32 v[66:67], v[66:67], v[30:31] op_sel_hi:[1,0]
    v_pk_mul_f32 v[68:69], v[68:69], v[30:31] op_sel_hi:[1,0]
    v_pk_mul_f32 v[70:71], v[70:71], v[30:31] op_sel_hi:[1,0]
    v_pk_mul_f32 v[72:73], v[72:73], v[30:31] op_sel_hi:[1,0]
    v_pk_mul_f32 v[74:75], v[74:75], v[30:31] op_sel_hi:[1,0]
    v_pk_mul_f32 v[76:77], v[76:77], v[30:31] op_sel_hi:[1,0]
    v_pk_mul_f32 v[78:79], v[78:79], v[30:31] op_sel_hi:[1,0]
    v_pk_fma_f32 v[128:129], v[128:129], v[28:29], v[64:65] op_sel_hi:[1,0,1]
    v_pk_fma_f32 v[130:131], v[130:131], v[28:29], v[66:67] op_sel_hi:[1,0,1]
    v_pk_fma_f32 v[132:133], v[132:133], v[28:29], v[68:69] op_sel_hi:[1,0,1]
    v_pk_fma_f32 v[134:135], v[134:135], v[28:29], v[70:71] op_sel_hi:[1,0,1]
    v_pk_fma_f32 v[136:137], v[136:137], v[28:29], v[72:73] op_sel_hi:[1,0,1]
    v_pk_fma_f32 v[138:139], v[138:139], v[28:29], v[74:75] op_sel_hi:[1,0,1]
    v_pk_fma_f32 v[140:141], v[140:141], v[28:29], v[76:77] op_sel_hi:[1,0,1]
    v_pk_fma_f32 v[142:143], v[142:143], v[28:29], v[78:79] op_sel_hi:[1,0,1]
    v_cvt_pk_bf16_f32 v48, v128, v129
    v_cvt_pk_bf16_f32 v49, v130, v131
    v_cvt_pk_bf16_f32 v50, v132, v133
    v_cvt_pk_bf16_f32 v51, v134, v135
    v_cvt_pk_bf16_f32 v52, v136, v137
    v_cvt_pk_bf16_f32 v53, v138, v139
    v_cvt_pk_bf16_f32 v54, v140, v141
    v_cvt_pk_bf16_f32 v55, v142, v143
    buffer_store_dwordx4 v[48:51], v27, s[32:35], s55 offen sc1
    buffer_store_dwordx4 v[52:55], v27, s[32:35], s59 offen sc1
    s_add_u32 s55, s56, 3
    s_cmp_lt_u32 s55, 16
    s_cselect_b32 s54, s60, 1.0
    v_mul_f32 v28, s54, v25
    v_mul_f32 v30, s54, v26
    s_cmp_ge_u32 s55, 32
    s_cselect_b64 vcc, -1, 0
    s_lshl_b32 s55, s55, 7
    s_add_u32 s55, s55, s58
    s_lshl_b32 s55, s55, 10
    s_add_u32 s59, s55, 65536
    v_cndmask_b32 v27, v20, v21, vcc
    v_pk_mul_f32 v[80:81], v[80:81], v[30:31] op_sel_hi:[1,0]
    v_pk_mul_f32 v[82:83], v[82:83], v[30:31] op_sel_hi:[1,0]
    v_pk_mul_f32 v[84:85], v[84:85], v[30:31] op_sel_hi:[1,0]
    v_pk_mul_f32 v[86:87], v[86:87], v[30:31] op_sel_hi:[1,0]
    v_pk_mul_f32 v[88:89], v[88:89], v[30:31] op_sel_hi:[1,0]
    v_pk_mul_f32 v[90:91], v[90:91], v[30:31] op_sel_hi:[1,0]
    v_pk_mul_f32 v[92:93], v[92:93], v[30:31] op_sel_hi:[1,0]
    v_pk_mul_f32 v[94:95], v[94:95], v[30:31] op_sel_hi:[1,0]
    v_pk_fma_f32 v[144:145], v[144:145], v[28:29], v[80:81] op_sel_hi:[1,0,1]
    v_pk_fma_f32 v[146:147], v[146:147], v[28:29], v[82:83] op_sel_hi:[1,0,1]
    v_pk_fma_f32 v[148:149], v[148:149], v[28:29], v[84:85] op_sel_hi:[1,0,1]
    v_pk_fma_f32 v[150:151], v[150:151], v[28:29], v[86:87] op_sel_hi:[1,0,1]
    v_pk_fma_f32 v[152:153], v[152:153], v[28:29], v[88:89] op_sel_hi:[1,0,1]
    v_pk_fma_f32 v[154:155], v[154:155], v[28:29], v[90:91] op_sel_hi:[1,0,1]
    v_pk_fma_f32 v[156:157], v[156:157], v[28:29], v[92:93] op_sel_hi:[1,0,1]
    v_pk_fma_f32 v[158:159], v[158:159], v[28:29], v[94:95] op_sel_hi:[1,0,1]
    v_cvt_pk_bf16_f32 v64, v144, v145
    v_cvt_pk_bf16_f32 v65, v146, v147
    v_cvt_pk_bf16_f32 v66, v148, v149
    v_cvt_pk_bf16_f32 v67, v150, v151
    v_cvt_pk_bf16_f32 v68, v152, v153
    v_cvt_pk_bf16_f32 v69, v154, v155
    v_cvt_pk_bf16_f32 v70, v156, v157
    v_cvt_pk_bf16_f32 v71, v158, v159
    buffer_store_dwordx4 v[64:67], v27, s[32:35], s55 offen sc1
    buffer_store_dwordx4 v[68:71], v27, s[32:35], s59 offen sc1
    s_branch L_k1_fin
L_k1_htiles:
    v_mul_f32 v28, v18, v25
    v_mul_f32 v30, v18, v26
    s_lshl_b32 s55, s41, 12
    s_add_u32 s55, s55, 6291456
    v_pk_mul_f32 v[64:65], v[64:65], v[30:31] op_sel_hi:[1,0]
    v_pk_mul_f32 v[66:67], v[66:67], v[30:31] op_sel_hi:[1,0]
    v_pk_mul_f32 v[68:69], v[68:69], v[30:31] op_sel_hi:[1,0]
    v_pk_mul_f32 v[70:71], v[70:71], v[30:31] op_sel_hi:[1,0]
    v_pk_mul_f32 v[72:73], v[72:73], v[30:31] op_sel_hi:[1,0]
    v_pk_mul_f32 v[74:75], v[74:75], v[30:31] op_sel_hi:[1,0]
    v_pk_mul_f32 v[76:77], v[76:77], v[30:31] op_sel_hi:[1,0]
    v_pk_mul_f32 v[78:79], v[78:79], v[30:31] op_sel_hi:[1,0]
    v_pk_fma_f32 v[128:129], v[128:129], v[28:29], v[64:65] op_sel_hi:[1,0,1]
    v_pk_fma_f32 v[130:131], v[130:131], v[28:29], v[66:67] op_sel_hi:[1,0,1]
    v_pk_fma_f32 v[132:133], v[132:133], v[28:29], v[68:69] op_sel_hi:[1,0,1]
    v_pk_fma_f32 v[134:135], v[134:135], v[28:29], v[70:71] op_sel_hi:[1,0,1]
    v_pk_fma_f32 v[136:137], v[136:137], v[28:29], v[72:73] op_sel_hi:[1,0,1]
    v_pk_fma_f32 v[138:139], v[138:139], v[28:29], v[74:75] op_sel_hi:[1,0,1]
    v_pk_fma_f32 v[140:141], v[140:141], v[28:29], v[76:77] op_sel_hi:[1,0,1]
    v_pk_fma_f32 v[142:143], v[142:143], v[28:29], v[78:79] op_sel_hi:[1,0,1]
    v_pk_mul_f32 v[64:65], v[128:129], v[128:129]
    v_pk_mul_f32 v[66:67], v[130:131], v[130:131]
    v_pk_mul_f32 v[68:69], v[132:133], v[132:133]
    v_pk_mul_f32 v[70:71], v[134:135], v[134:135]
    v_pk_mul_f32 v[72:73], v[136:137], v[136:137]
    v_pk_mul_f32 v[74:75], v[138:139], v[138:139]
    v_pk_mul_f32 v[76:77], v[140:141], v[140:141]
    v_pk_mul_f32 v[78:79], v[142:143], v[142:143]
    v_pk_fma_f32 v[64:65], v[64:65], s[62:63], v[16:17] op_sel_hi:[1,1,0]
    v_pk_fma_f32 v[66:67], v[66:67], s[62:63], v[16:17] op_sel_hi:[1,1,0]
    v_pk_fma_f32 v[68:69], v[68:69], s[62:63], v[16:17] op_sel_hi:[1,1,0]
    v_pk_fma_f32 v[70:71], v[70:71], s[62:63], v[16:17] op_sel_hi:[1,1,0]
    v_pk_fma_f32 v[72:73], v[72:73], s[62:63], v[16:17] op_sel_hi:[1,1,0]
    v_pk_fma_f32 v[74:75], v[74:75], s[62:63], v[16:17] op_sel_hi:[1,1,0]
    v_pk_fma_f32 v[76:77], v[76:77], s[62:63], v[16:17] op_sel_hi:[1,1,0]
    v_pk_fma_f32 v[78:79], v[78:79], s[62:63], v[16:17] op_sel_hi:[1,1,0]
    v_pk_mul_f32 v[64:65], v[64:65], v[128:129]
    v_pk_mul_f32 v[66:67], v[66:67], v[130:131]
    v_pk_mul_f32 v[68:69], v[68:69], v[132:133]
    v_pk_mul_f32 v[70:71], v[70:71], v[134:135]
    v_pk_mul_f32 v[72:73], v[72:73], v[136:137]
    v_pk_mul_f32 v[74:75], v[74:75], v[138:139]
    v_pk_mul_f32 v[76:77], v[76:77], v[140:141]
    v_pk_mul_f32 v[78:79], v[78:79], v[142:143]
    v_exp_f32 v64, v64
    v_exp_f32 v65, v65
    v_exp_f32 v66, v66
    v_exp_f32 v67, v67
    v_exp_f32 v68, v68
    v_exp_f32 v69, v69
    v_exp_f32 v70, v70
    v_exp_f32 v71, v71
    v_exp_f32 v72, v72
    v_exp_f32 v73, v73
    v_exp_f32 v74, v74
    v_exp_f32 v75, v75
    v_exp_f32 v76, v76
    v_exp_f32 v77, v77
    v_exp_f32 v78, v78
    v_exp_f32 v79, v79
    v_pk_add_f32 v[64:65], v[64:65], 1.0 op_sel_hi:[1,0]
    v_pk_add_f32 v[66:67], v[66:67], 1.0 op_sel_hi:[1,0]
    v_pk_add_f32 v[68:69], v[68:69], 1.0 op_sel_hi:[1,0]
    v_pk_add_f32 v[70:71], v[70:71], 1.0 op_sel_hi:[1,0]
    v_pk_add_f32 v[72:73], v[72:73], 1.0 op_sel_hi:[1,0]
    v_pk_add_f32 v[74:75], v[74:75], 1.0 op_sel_hi:[1,0]
    v_pk_add_f32 v[76:77], v[76:77], 1.0 op_sel_hi:[1,0]
    v_pk_add_f32 v[78:79], v[78:79], 1.0 op_sel_hi:[1,0]
    v_rcp_f32 v64, v64
    v_rcp_f32 v65, v65
    v_rcp_f32 v66, v66
    v_rcp_f32 v67, v67
    v_rcp_f32 v68, v68
    v_rcp_f32 v69, v69
    v_rcp_f32 v70, v70
    v_rcp_f32 v71, v71
    v_rcp_f32 v72, v72
    v_rcp_f32 v73, v73
    v_rcp_f32 v74, v74
    v_rcp_f32 v75, v75
    v_rcp_f32 v76, v76
    v_rcp_f32 v77, v77
    v_rcp_f32 v78, v78
    v_rcp_f32 v79, v79
    v_pk_mul_f32 v[128:129], v[128:129], v[64:65]
    v_pk_mul_f32 v[130:131], v[130:131], v[66:67]
    v_pk_mul_f32 v[132:133], v[132:133], v[68:69]
    v_pk_mul_f32 v[134:135], v[134:135], v[70:71]
    v_pk_mul_f32 v[136:137], v[136:137], v[72:73]
    v_pk_mul_f32 v[138:139], v[138:139], v[74:75]
    v_pk_mul_f32 v[140:141], v[140:141], v[76:77]
    v_pk_mul_f32 v[142:143], v[142:143], v[78:79]
    v_cvt_pk_bf16_f32 v48, v128, v129
    v_cvt_pk_bf16_f32 v49, v130, v131
    v_cvt_pk_bf16_f32 v50, v132, v133
    v_cvt_pk_bf16_f32 v51, v134, v135
    v_cvt_pk_bf16_f32 v52, v136, v137
    v_cvt_pk_bf16_f32 v53, v138, v139
    v_cvt_pk_bf16_f32 v54, v140, v141
    v_cvt_pk_bf16_f32 v55, v142, v143
    buffer_store_dwordx4 v[48:51], v23, s[32:35], s55 offen sc1
    buffer_store_dwordx4 v[52:55], v23, s[32:35], s55 offen offset:1024 sc1
    v_mul_f32 v28, v18, v25
    v_mul_f32 v30, v18, v26
    s_lshl_b32 s55, s41, 12
    s_add_u32 s55, s55, 6293504
    v_pk_mul_f32 v[80:81], v[80:81], v[30:31] op_sel_hi:[1,0]
    v_pk_mul_f32 v[82:83], v[82:83], v[30:31] op_sel_hi:[1,0]
    v_pk_mul_f32 v[84:85], v[84:85], v[30:31] op_sel_hi:[1,0]
    v_pk_mul_f32 v[86:87], v[86:87], v[30:31] op_sel_hi:[1,0]
    v_pk_mul_f32 v[88:89], v[88:89], v[30:31] op_sel_hi:[1,0]
    v_pk_mul_f32 v[90:91], v[90:91], v[30:31] op_sel_hi:[1,0]
    v_pk_mul_f32 v[92:93], v[92:93], v[30:31] op_sel_hi:[1,0]
    v_pk_mul_f32 v[94:95], v[94:95], v[30:31] op_sel_hi:[1,0]
    v_pk_fma_f32 v[144:145], v[144:145], v[28:29], v[80:81] op_sel_hi:[1,0,1]
    v_pk_fma_f32 v[146:147], v[146:147], v[28:29], v[82:83] op_sel_hi:[1,0,1]
    v_pk_fma_f32 v[148:149], v[148:149], v[28:29], v[84:85] op_sel_hi:[1,0,1]
    v_pk_fma_f32 v[150:151], v[150:151], v[28:29], v[86:87] op_sel_hi:[1,0,1]
    v_pk_fma_f32 v[152:153], v[152:153], v[28:29], v[88:89] op_sel_hi:[1,0,1]
    v_pk_fma_f32 v[154:155], v[154:155], v[28:29], v[90:91] op_sel_hi:[1,0,1]
    v_pk_fma_f32 v[156:157], v[156:157], v[28:29], v[92:93] op_sel_hi:[1,0,1]
    v_pk_fma_f32 v[158:159], v[158:159], v[28:29], v[94:95] op_sel_hi:[1,0,1]
    v_pk_mul_f32 v[80:81], v[144:145], v[144:145]
    v_pk_mul_f32 v[82:83], v[146:147], v[146:147]
    v_pk_mul_f32 v[84:85], v[148:149], v[148:149]
    v_pk_mul_f32 v[86:87], v[150:151], v[150:151]
    v_pk_mul_f32 v[88:89], v[152:153], v[152:153]
    v_pk_mul_f32 v[90:91], v[154:155], v[154:155]
    v_pk_mul_f32 v[92:93], v[156:157], v[156:157]
    v_pk_mul_f32 v[94:95], v[158:159], v[158:159]
    v_pk_fma_f32 v[80:81], v[80:81], s[62:63], v[16:17] op_sel_hi:[1,1,0]
    v_pk_fma_f32 v[82:83], v[82:83], s[62:63], v[16:17] op_sel_hi:[1,1,0]
    v_pk_fma_f32 v[84:85], v[84:85], s[62:63], v[16:17] op_sel_hi:[1,1,0]
    v_pk_fma_f32 v[86:87], v[86:87], s[62:63], v[16:17] op_sel_hi:[1,1,0]
    v_pk_fma_f32 v[88:89], v[88:89], s[62:63], v[16:17] op_sel_hi:[1,1,0]
    v_pk_fma_f32 v[90:91], v[90:91], s[62:63], v[16:17] op_sel_hi:[1,1,0]
    v_pk_fma_f32 v[92:93], v[92:93], s[62:63], v[16:17] op_sel_hi:[1,1,0]
    v_pk_fma_f32 v[94:95], v[94:95], s[62:63], v[16:17] op_sel_hi:[1,1,0]
    v_pk_mul_f32 v[80:81], v[80:81], v[144:145]
    v_pk_mul_f32 v[82:83], v[82:83], v[146:147]
    v_pk_mul_f32 v[84:85], v[84:85], v[148:149]
    v_pk_mul_f32 v[86:87], v[86:87], v[150:151]
    v_pk_mul_f32 v[88:89], v[88:89], v[152:153]
    v_pk_mul_f32 v[90:91], v[90:91], v[154:155]
    v_pk_mul_f32 v[92:93], v[92:93], v[156:157]
    v_pk_mul_f32 v[94:95], v[94:95], v[158:159]
    v_exp_f32 v80, v80
    v_exp_f32 v81, v81
    v_exp_f32 v82, v82
    v_exp_f32 v83, v83
    v_exp_f32 v84, v84
    v_exp_f32 v85, v85
    v_exp_f32 v86, v86
    v_exp_f32 v87, v87
    v_exp_f32 v88, v88
    v_exp_f32 v89, v89
    v_exp_f32 v90, v90
    v_exp_f32 v91, v91
    v_exp_f32 v92, v92
    v_exp_f32 v93, v93
    v_exp_f32 v94, v94
    v_exp_f32 v95, v95
    v_pk_add_f32 v[80:81], v[80:81], 1.0 op_sel_hi:[1,0]
    v_pk_add_f32 v[82:83], v[82:83], 1.0 op_sel_hi:[1,0]
    v_pk_add_f32 v[84:85], v[84:85], 1.0 op_sel_hi:[1,0]
    v_pk_add_f32 v[86:87], v[86:87], 1.0 op_sel_hi:[1,0]
    v_pk_add_f32 v[88:89], v[88:89], 1.0 op_sel_hi:[1,0]
    v_pk_add_f32 v[90:91], v[90:91], 1.0 op_sel_hi:[1,0]
    v_pk_add_f32 v[92:93], v[92:93], 1.0 op_sel_hi:[1,0]
    v_pk_add_f32 v[94:95], v[94:95], 1.0 op_sel_hi:[1,0]
    v_rcp_f32 v80, v80
    v_rcp_f32 v81, v81
    v_rcp_f32 v82, v82
    v_rcp_f32 v83, v83
    v_rcp_f32 v84, v84
    v_rcp_f32 v85, v85
    v_rcp_f32 v86, v86
    v_rcp_f32 v87, v87
    v_rcp_f32 v88, v88
    v_rcp_f32 v89, v89
    v_rcp_f32 v90, v90
    v_rcp_f32 v91, v91
    v_rcp_f32 v92, v92
    v_rcp_f32 v93, v93
    v_rcp_f32 v94, v94
    v_rcp_f32 v95, v95
    v_pk_mul_f32 v[144:145], v[144:145], v[80:81]
    v_pk_mul_f32 v[146:147], v[146:147], v[82:83]
    v_pk_mul_f32 v[148:149], v[148:149], v[84:85]
    v_pk_mul_f32 v[150:151], v[150:151], v[86:87]
    v_pk_mul_f32 v[152:153], v[152:153], v[88:89]
    v_pk_mul_f32 v[154:155], v[154:155], v[90:91]
    v_pk_mul_f32 v[156:157], v[156:157], v[92:93]
    v_pk_mul_f32 v[158:159], v[158:159], v[94:95]
    v_cvt_pk_bf16_f32 v64, v144, v145
    v_cvt_pk_bf16_f32 v65, v146, v147
    v_cvt_pk_bf16_f32 v66, v148, v149
    v_cvt_pk_bf16_f32 v67, v150, v151
    v_cvt_pk_bf16_f32 v68, v152, v153
    v_cvt_pk_bf16_f32 v69, v154, v155
    v_cvt_pk_bf16_f32 v70, v156, v157
    v_cvt_pk_bf16_f32 v71, v158, v159
    buffer_store_dwordx4 v[64:67], v23, s[32:35], s55 offen sc1
    buffer_store_dwordx4 v[68:71], v23, s[32:35], s55 offen offset:1024 sc1
L_k1_fin:
L_k1_exit:
    s_endpgm
.globl k2_kernel
.p2align 8
.type k2_kernel,@function
k2_kernel:
    s_cmp_ge_u32 s2, 256
    s_cbranch_scc1 L_k2_exit
    s_load_dwordx2 s[4:5], s[0:1], 0
    s_load_dwordx2 s[6:7], s[0:1], 64
    s_load_dwordx2 s[20:21], s[0:1], 80
    v_lshrrev_b32 v1, 6, v0
    s_and_b32 s54, s2, 7
    v_readfirstlane_b32 s44, v1
    v_and_b32 v1, 63, v0
    v_lshlrev_b32 v2, 4, v1
    s_lshl_b32 s40, s54, 2
    s_bfe_u32 s54, s2, 0x20003
    s_add_u32 s40, s40, s54
    s_lshr_b32 s41, s2, 5
    s_mov_b32 s45, s44
    v_mov_b32 v4, 0
    v_mov_b32 v5, 0
    v_mov_b32 v6, 0
    v_mov_b32 v7, 0
    v_add_u32 v3, 161280, v2
    ds_write_b128 v3, v[4:7]
    s_waitcnt lgkmcnt(0)
    s_barrier
    s_mov_b32 s32, s20
    s_and_b32 s33, s21, 0xffff
    s_mov_b32 s34, 41943040
    s_mov_b32 s35, 0x00020000
    s_cmp_ge_u32 s44, 8
    s_cbranch_scc1 L_k2_b
    s_and_b32 s46, s45, 3
    s_lshr_b32 s47, s45, 2
    s_lshl_b32 s48, s41, 3
    s_lshl_b32 s49, s46, 1
    s_add_u32 s48, s48, s49
    s_add_u32 s48, s48, s47
    s_xor_b32 s49, s48, 1
    s_lshl_b32 s50, s40, 6
    s_add_u32 s51, s50, s48
    s_lshl_b32 s51, s51, 10
    s_add_u32 s52, s50, s49
    s_lshl_b32 s52, s52, 10
    buffer_load_dwordx4 v[8:11], v2, s[32:35], s51 offen
    buffer_load_dwordx4 v[12:15], v2, s[32:35], s52 offen
    v_and_b32 v5, 1, v1
    v_cmp_eq_u32 vcc, 0, v5
    v_mov_b32 v5, 0x3f80
    v_mov_b32 v33, 0
    v_mov_b32 v35, 0
    v_cndmask_b32 v32, 0, v5, vcc
    v_mov_b32 v34, v32
    v_lshlrev_b32 v3, 4, v0
    v_cmp_gt_u32 vcc, 5632, v3
    v_add_u32 v3, 131072, v3
    s_and_saveexec_b64 s[50:51], vcc
    ds_write_b128 v3, v[32:35]
    s_mov_b64 exec, -1
    v_lshrrev_b32 v5, 5, v1
    v_bfe_u32 v6, v1, 4, 1
    v_xor_b32 v7, v5, v6
    v_and_b32 v3, 15, v1
    v_lshlrev_b32 v3, 3, v3
    v_lshl_add_u32 v3, v7, 7, v3
    s_lshl_b32 s53, s47, 15
    s_add_u32 s51, s53, 65536
    v_mov_b32 v7, s51
    v_mov_b32 v160, 131072
    v_cmp_eq_u32 vcc, 1, v6
    v_xor_b32 v4, 1, v6
    v_lshlrev_b32 v4, 12, v4
    v_cndmask_b32 v7, v7, v160, vcc
    v_add_u32 v160, v7, v3
    v_add_u32 v165, s53, v2
    s_mov_b32 s56, 0
    s_lshl_b32 s51, s45, 2
    s_add_u32 s51, s51, 162112
    v_mov_b32 v161, s51
    v_xor_b32 v162, 16, v161
    v_mov_b32 v163, 0
    v_mov_b32 v164, 0
    s_waitcnt lgkmcnt(0)
    v_mov_b32 v5, 162084
    v_mov_b32 v6, 1
    s_mov_b64 exec, 1
    ds_add_u32 v5, v6
    s_mov_b64 exec, -1
    v_mov_b32 v5, 162084
    s_mov_b32 s51, 20000
L_k2_lwc0:
    ds_read_b32 v6, v5
    s_waitcnt lgkmcnt(0)
    v_readfirstlane_b32 s52, v6
    s_cmp_ge_u32 s52, 12
    s_cbranch_scc1 L_k2_lwc0_go
    s_sleep 1
    s_sub_u32 s51, s51, 1
    s_cmp_lg_u32 s51, 0
    s_cbranch_scc1 L_k2_lwc0
L_k2_lwc0_go:
    ds_read_b128 v[112:115], v165
    s_waitcnt vmcnt(0) lgkmcnt(0)
    v_mfma_f32_32x32x16_bf16 v[32:47], v[112:115], v[8:11], 0
    v_mfma_f32_32x32x16_bf16 v[48:63], v[112:115], v[12:15], 0
    s_nop 7
    s_nop 3
    v_max3_f32 v16, v32, v33, v34
    v_max3_f32 v17, v35, v36, v37
    v_max3_f32 v16, v16, v38, v39
    v_max3_f32 v17, v17, v40, v41
    v_max3_f32 v16, v16, v42, v43
    v_max3_f32 v17, v17, v44, v45
    v_max3_f32 v16, v16, v46, v47
    v_max3_f32 v144, v48, v49, v50
    v_max3_f32 v145, v51, v52, v53
    v_max3_f32 v144, v144, v54, v55
    v_max3_f32 v145, v145, v56, v57
    v_max3_f32 v144, v144, v58, v59
    v_max3_f32 v145, v145, v60, v61
    v_max3_f32 v144, v144, v62, v63
L_k2_setmax:
    v_max_f32 v16, v16, v17
    v_max_f32 v144, v144, v145
    v_mov_b32 v17, v16
    v_mov_b32 v145, v144
    v_mov_b32 v120, v165
    v_mov_b32 v3, v160
    v_permlane32_swap_b32 v16, v17
    v_permlane32_swap_b32 v144, v145
    ds_read_b128 v[112:115], v120
    ds_read_b128 v[116:119], v120 offset:1024
    ds_read_b64_tr_b16 v[128:129], v3 offset:0
    ds_read_b64_tr_b16 v[130:131], v3 offset:256
    ds_read_b64_tr_b16 v[132:133], v3 offset:512
    ds_read_b64_tr_b16 v[134:135], v3 offset:768
    v_max_f32 v16, v16, v17
    v_max_f32 v144, v144, v145
    v_sub_f32 v16, 0, v16
    v_sub_f32 v144, 0, v144
    v_mov_b32 v17, v16
    v_mov_b32 v18, v16
    v_mov_b32 v19, v16
    v_mov_b32 v20, v16
    v_mov_b32 v21, v16
    v_mov_b32 v22, v16
    v_mov_b32 v23, v16
    v_mov_b32 v24, v16
    v_mov_b32 v25, v16
    v_mov_b32 v26, v16
    v_mov_b32 v27, v16
    v_mov_b32 v28, v16
    v_mov_b32 v29, v16
    v_mov_b32 v30, v16
    v_mov_b32 v31, v16
    v_mov_b32 v145, v144
    v_mov_b32 v146, v144
    v_mov_b32 v147, v144
    v_mov_b32 v148, v144
    v_mov_b32 v149, v144
    v_mov_b32 v150, v144
    v_mov_b32 v151, v144
    v_mov_b32 v152, v144
    v_mov_b32 v153, v144
    v_mov_b32 v154, v144
    v_mov_b32 v155, v144
    v_mov_b32 v156, v144
    v_mov_b32 v157, v144
    v_mov_b32 v158, v144
    v_mov_b32 v159, v144
    v_mov_b32 v76, 0
    v_mov_b32 v77, 0
    v_mov_b32 v78, 0
    v_mov_b32 v79, 0
    v_mov_b32 v80, 0
    v_mov_b32 v81, 0
    v_mov_b32 v82, 0
    v_mov_b32 v83, 0
    v_mov_b32 v84, 0
    v_mov_b32 v85, 0
    v_mov_b32 v86, 0
    v_mov_b32 v87, 0
    v_mov_b32 v88, 0
    v_mov_b32 v89, 0
    v_mov_b32 v90, 0
    v_mov_b32 v91, 0
    v_mov_b32 v92, 0
    v_mov_b32 v93, 0
    v_mov_b32 v94, 0
    v_mov_b32 v95, 0
    v_mov_b32 v96, 0
    v_mov_b32 v97, 0
    v_mov_b32 v98, 0
    v_mov_b32 v99, 0
    v_mov_b32 v100, 0
    v_mov_b32 v101, 0
    v_mov_b32 v102, 0
    v_mov_b32 v103, 0
    v_mov_b32 v104, 0
    v_mov_b32 v105, 0
    v_mov_b32 v106, 0
    v_mov_b32 v107, 0
    v_mov_b32 v108, 0
    v_mov_b32 v109, 0
    v_mov_b32 v110, 0
    v_mov_b32 v111, 0
    v_mov_b32 v136, 0
    v_mov_b32 v137, 0
    v_mov_b32 v138, 0
    v_mov_b32 v139, 0
    v_mov_b32 v140, 0
    v_mov_b32 v141, 0
    v_mov_b32 v142, 0
    v_mov_b32 v143, 0
    s_waitcnt lgkmcnt(5)
    v_mfma_f32_32x32x16_bf16 v[32:47], v[112:115], v[8:11], v[16:31]
    s_nop 7
    s_nop 3
    s_mov_b32 s55, 0
L_k2_loop:
    s_cmp_eq_u32 s55, 1
    s_cbranch_scc1 L_k2_g
    s_cmp_lg_u32 s55, 3
    s_cbranch_scc1 L_k2_nobar
L_k2_g:
    s_lshl_b32 s51, s55, 2
    s_add_u32 s51, s51, 162084
    v_mov_b32 v5, s51
    s_mov_b32 s51, 20000
L_k2_lwc1:
    ds_read_b32 v6, v5
    s_waitcnt lgkmcnt(0)
    v_readfirstlane_b32 s52, v6
    s_cmp_ge_u32 s52, 4
    s_cbranch_scc1 L_k2_lwc1_go
    s_sleep 1
    s_sub_u32 s51, s51, 1
    s_cmp_lg_u32 s51, 0
    s_cbranch_scc1 L_k2_lwc1
L_k2_lwc1_go:
L_k2_nobar:
    v_exp_f32 v32, v32
    v_exp_f32 v33, v33
    v_mfma_f32_32x32x16_bf16 v[96:111], v[140:143], v[76:79], v[96:111]
    ds_read_b64_tr_b16 v[136:137], v3 offset:1024
    ds_read_b64_tr_b16 v[138:139], v3 offset:1280
    ds_read_b64_tr_b16 v[140:141], v3 offset:1536
    ds_read_b64_tr_b16 v[142:143], v3 offset:1792
    v_exp_f32 v34, v34
    v_exp_f32 v35, v35
    v_exp_f32 v36, v36
    v_exp_f32 v37, v37
    v_exp_f32 v38, v38
    v_exp_f32 v39, v39
    v_mfma_f32_32x32x16_bf16 v[48:63], v[112:115], v[12:15], v[144:159]
    ds_read_b128 v[112:115], v120 offset:2048
    v_exp_f32 v40, v40
    v_cvt_pk_bf16_f32 v64, v32, v33
    v_cvt_pk_bf16_f32 v65, v34, v35
    v_cvt_pk_bf16_f32 v66, v36, v37
    v_cvt_pk_bf16_f32 v67, v38, v39
    v_exp_f32 v41, v41
    v_exp_f32 v42, v42
    v_exp_f32 v43, v43
    s_waitcnt lgkmcnt(5)
    v_mfma_f32_32x32x16_bf16 v[80:95], v[128:131], v[64:67], v[80:95]
    ds_write_b32 v161, v163
    ds_read_b32 v164, v162
    v_exp_f32 v44, v44
    v_exp_f32 v45, v45
    v_exp_f32 v46, v46
    v_exp_f32 v47, v47
    v_exp_f32 v48, v48
    v_cvt_pk_bf16_f32 v68, v40, v41
    v_cvt_pk_bf16_f32 v69, v42, v43
    v_cvt_pk_bf16_f32 v70, v44, v45
    v_cvt_pk_bf16_f32 v71, v46, v47
    v_exp_f32 v49, v49
    v_exp_f32 v50, v50
    v_mfma_f32_32x32x16_bf16 v[80:95], v[132:135], v[68:71], v[80:95]
    v_exp_f32 v51, v51
    v_exp_f32 v52, v52
    v_exp_f32 v53, v53
    v_exp_f32 v54, v54
    v_exp_f32 v55, v55
    v_exp_f32 v56, v56
    v_mfma_f32_32x32x16_bf16 v[32:47], v[116:119], v[8:11], v[16:31]
    v_cvt_pk_bf16_f32 v72, v48, v49
    v_cvt_pk_bf16_f32 v73, v50, v51
    v_cvt_pk_bf16_f32 v74, v52, v53
    v_cvt_pk_bf16_f32 v75, v54, v55
    v_exp_f32 v57, v57
    v_exp_f32 v58, v58
    v_exp_f32 v59, v59
    v_exp_f32 v60, v60
    v_mfma_f32_32x32x16_bf16 v[96:111], v[128:131], v[72:75], v[96:111]
    v_exp_f32 v61, v61
    v_exp_f32 v62, v62
    v_exp_f32 v63, v63
    s_waitcnt lgkmcnt(0)
    v_cvt_pk_bf16_f32 v76, v56, v57
    v_cvt_pk_bf16_f32 v77, v58, v59
    v_cvt_pk_bf16_f32 v78, v60, v61
    v_cvt_pk_bf16_f32 v79, v62, v63
    v_exp_f32 v32, v32
    v_exp_f32 v33, v33
    v_mfma_f32_32x32x16_bf16 v[96:111], v[132:135], v[76:79], v[96:111]
    ds_read_b64_tr_b16 v[128:129], v3 offset:2048
    ds_read_b64_tr_b16 v[130:131], v3 offset:2304
    ds_read_b64_tr_b16 v[132:133], v3 offset:2560
    ds_read_b64_tr_b16 v[134:135], v3 offset:2816
    v_readfirstlane_b32 s51, v164
    v_add_u32 v163, 1, v163
    s_lshl_b32 s52, s55, 1
    s_add_u32 s52, s52, 0
    s_cmp_gt_u32 s52, s51
    s_cbranch_scc1 L_k2_lo1
    s_setprio 1
    s_branch L_k2_pd1
L_k2_lo1:
    s_setprio 0
L_k2_pd1:
    v_exp_f32 v34, v34
    v_exp_f32 v35, v35
    v_exp_f32 v36, v36
    v_exp_f32 v37, v37
    v_exp_f32 v38, v38
    v_exp_f32 v39, v39
    v_mfma_f32_32x32x16_bf16 v[48:63], v[116:119], v[12:15], v[144:159]
    ds_read_b128 v[116:119], v120 offset:3072
    v_exp_f32 v40, v40
    v_cvt_pk_bf16_f32 v64, v32, v33
    v_cvt_pk_bf16_f32 v65, v34, v35
    v_cvt_pk_bf16_f32 v66, v36, v37
    v_cvt_pk_bf16_f32 v67, v38, v39
    v_exp_f32 v41, v41
    v_exp_f32 v42, v42
    v_exp_f32 v43, v43
    s_waitcnt lgkmcnt(5)
    v_mfma_f32_32x32x16_bf16 v[80:95], v[136:139], v[64:67], v[80:95]
    v_exp_f32 v44, v44
    v_exp_f32 v45, v45
    v_exp_f32 v46, v46
    v_exp_f32 v47, v47
    v_exp_f32 v48, v48
    v_cvt_pk_bf16_f32 v68, v40, v41
    v_cvt_pk_bf16_f32 v69, v42, v43
    v_cvt_pk_bf16_f32 v70, v44, v45
    v_cvt_pk_bf16_f32 v71, v46, v47
    v_exp_f32 v49, v49
    v_exp_f32 v50, v50
    v_mfma_f32_32x32x16_bf16 v[80:95], v[140:143], v[68:71], v[80:95]
    v_exp_f32 v51, v51
    v_exp_f32 v52, v52
    v_exp_f32 v53, v53
    v_exp_f32 v54, v54
    v_exp_f32 v55, v55
    v_exp_f32 v56, v56
    v_mfma_f32_32x32x16_bf16 v[32:47], v[112:115], v[8:11], v[16:31]
    v_cvt_pk_bf16_f32 v72, v48, v49
    v_cvt_pk_bf16_f32 v73, v50, v51
    v_cvt_pk_bf16_f32 v74, v52, v53
    v_cvt_pk_bf16_f32 v75, v54, v55
    v_exp_f32 v57, v57
    v_exp_f32 v58, v58
    v_exp_f32 v59, v59
    v_exp_f32 v60, v60
    v_mfma_f32_32x32x16_bf16 v[96:111], v[136:139], v[72:75], v[96:111]
    v_exp_f32 v61, v61
    v_exp_f32 v62, v62
    v_exp_f32 v63, v63
    s_nop 0
    v_cvt_pk_bf16_f32 v76, v56, v57
    v_cvt_pk_bf16_f32 v77, v58, v59
    v_cvt_pk_bf16_f32 v78, v60, v61
    v_cvt_pk_bf16_f32 v79, v62, v63
    v_exp_f32 v32, v32
    v_exp_f32 v33, v33
    v_mfma_f32_32x32x16_bf16 v[96:111], v[140:143], v[76:79], v[96:111]
    ds_read_b64_tr_b16 v[136:137], v3 offset:3072
    ds_read_b64_tr_b16 v[138:139], v3 offset:3328
    ds_read_b64_tr_b16 v[140:141], v3 offset:3584
    ds_read_b64_tr_b16 v[142:143], v3 offset:3840
    v_exp_f32 v34, v34
    v_exp_f32 v35, v35
    v_exp_f32 v36, v36
    v_exp_f32 v37, v37
    v_exp_f32 v38, v38
    v_exp_f32 v39, v39
    v_mfma_f32_32x32x16_bf16 v[48:63], v[112:115], v[12:15], v[144:159]
    ds_read_b128 v[112:115], v120 offset:4096
    v_exp_f32 v40, v40
    v_cvt_pk_bf16_f32 v64, v32, v33
    v_cvt_pk_bf16_f32 v65, v34, v35
    v_cvt_pk_bf16_f32 v66, v36, v37
    v_cvt_pk_bf16_f32 v67, v38, v39
    v_exp_f32 v41, v41
    v_exp_f32 v42, v42
    v_exp_f32 v43, v43
    s_waitcnt lgkmcnt(5)
    v_mfma_f32_32x32x16_bf16 v[80:95], v[128:131], v[64:67], v[80:95]
    ds_write_b32 v161, v163
    ds_read_b32 v164, v162
    v_exp_f32 v44, v44
    v_exp_f32 v45, v45
    v_exp_f32 v46, v46
    v_exp_f32 v47, v47
    v_exp_f32 v48, v48
    v_cvt_pk_bf16_f32 v68, v40, v41
    v_cvt_pk_bf16_f32 v69, v42, v43
    v_cvt_pk_bf16_f32 v70, v44, v45
    v_cvt_pk_bf16_f32 v71, v46, v47
    v_exp_f32 v49, v49
    v_exp_f32 v50, v50
    v_mfma_f32_32x32x16_bf16 v[80:95], v[132:135], v[68:71], v[80:95]
    v_exp_f32 v51, v51
    v_exp_f32 v52, v52
    v_exp_f32 v53, v53
    v_exp_f32 v54, v54
    v_exp_f32 v55, v55
    v_exp_f32 v56, v56
    v_mfma_f32_32x32x16_bf16 v[32:47], v[116:119], v[8:11], v[16:31]
    v_cvt_pk_bf16_f32 v72, v48, v49
    v_cvt_pk_bf16_f32 v73, v50, v51
    v_cvt_pk_bf16_f32 v74, v52, v53
    v_cvt_pk_bf16_f32 v75, v54, v55
    v_exp_f32 v57, v57
    v_exp_f32 v58, v58
    v_exp_f32 v59, v59
    v_exp_f32 v60, v60
    v_mfma_f32_32x32x16_bf16 v[96:111], v[128:131], v[72:75], v[96:111]
    v_exp_f32 v61, v61
    v_exp_f32 v62, v62
    v_exp_f32 v63, v63
    s_waitcnt lgkmcnt(0)
    v_cvt_pk_bf16_f32 v76, v56, v57
    v_cvt_pk_bf16_f32 v77, v58, v59
    v_cvt_pk_bf16_f32 v78, v60, v61
    v_cvt_pk_bf16_f32 v79, v62, v63
    v_exp_f32 v32, v32
    v_exp_f32 v33, v33
    v_mfma_f32_32x32x16_bf16 v[96:111], v[132:135], v[76:79], v[96:111]
    ds_read_b64_tr_b16 v[128:129], v3 offset:4096
    ds_read_b64_tr_b16 v[130:131], v3 offset:4352
    ds_read_b64_tr_b16 v[132:133], v3 offset:4608
    ds_read_b64_tr_b16 v[134:135], v3 offset:4864
    v_readfirstlane_b32 s51, v164
    v_add_u32 v163, 1, v163
    s_lshl_b32 s52, s55, 1
    s_add_u32 s52, s52, 1
    s_cmp_gt_u32 s52, s51
    s_cbranch_scc1 L_k2_lo3
    s_setprio 1
    s_branch L_k2_pd3
L_k2_lo3:
    s_setprio 0
L_k2_pd3:
    v_exp_f32 v34, v34
    v_exp_f32 v35, v35
    v_exp_f32 v36, v36
    v_exp_f32 v37, v37
    v_exp_f32 v38, v38
    v_exp_f32 v39, v39
    v_mfma_f32_32x32x16_bf16 v[48:63], v[116:119], v[12:15], v[144:159]
    ds_read_b128 v[116:119], v120 offset:5120
    v_exp_f32 v40, v40
    v_cvt_pk_bf16_f32 v64, v32, v33
    v_cvt_pk_bf16_f32 v65, v34, v35
    v_cvt_pk_bf16_f32 v66, v36, v37
    v_cvt_pk_bf16_f32 v67, v38, v39
    v_exp_f32 v41, v41
    v_exp_f32 v42, v42
    v_exp_f32 v43, v43
    s_waitcnt lgkmcnt(5)
    v_mfma_f32_32x32x16_bf16 v[80:95], v[136:139], v[64:67], v[80:95]
    v_exp_f32 v44, v44
    v_exp_f32 v45, v45
    v_exp_f32 v46, v46
    v_exp_f32 v47, v47
    v_exp_f32 v48, v48
    v_cvt_pk_bf16_f32 v68, v40, v41
    v_cvt_pk_bf16_f32 v69, v42, v43
    v_cvt_pk_bf16_f32 v70, v44, v45
    v_cvt_pk_bf16_f32 v71, v46, v47
    v_exp_f32 v49, v49
    v_exp_f32 v50, v50
    v_mfma_f32_32x32x16_bf16 v[80:95], v[140:143], v[68:71], v[80:95]
    v_exp_f32 v51, v51
    v_exp_f32 v52, v52
    v_exp_f32 v53, v53
    v_exp_f32 v54, v54
    v_exp_f32 v55, v55
    v_exp_f32 v56, v56
    v_mfma_f32_32x32x16_bf16 v[32:47], v[112:115], v[8:11], v[16:31]
    v_cvt_pk_bf16_f32 v72, v48, v49
    v_cvt_pk_bf16_f32 v73, v50, v51
    v_cvt_pk_bf16_f32 v74, v52, v53
    v_cvt_pk_bf16_f32 v75, v54, v55
    v_exp_f32 v57, v57
    v_exp_f32 v58, v58
    v_exp_f32 v59, v59
    v_exp_f32 v60, v60
    v_mfma_f32_32x32x16_bf16 v[96:111], v[136:139], v[72:75], v[96:111]
    v_exp_f32 v61, v61
    v_exp_f32 v62, v62
    v_exp_f32 v63, v63
    v_add_u32 v3, v4, v3
    v_add_u32 v120, 4096, v120
    v_cvt_pk_bf16_f32 v76, v56, v57
    v_cvt_pk_bf16_f32 v77, v58, v59
    v_cvt_pk_bf16_f32 v78, v60, v61
    v_cvt_pk_bf16_f32 v79, v62, v63
    s_add_u32 s55, s55, 1
    s_cmp_lt_u32 s55, 8
    s_cbranch_scc1 L_k2_loop
    v_mfma_f32_32x32x16_bf16 v[96:111], v[140:143], v[76:79], v[96:111]
    s_waitcnt lgkmcnt(0)
    s_nop 7
    s_nop 3
    v_mul_f32 v32, 0, v80
    v_fma_f32 v32, v81, 0, v32
    v_fma_f32 v32, v82, 0, v32
    v_fma_f32 v32, v83, 0, v32
    v_fma_f32 v32, v84, 0, v32
    v_fma_f32 v32, v85, 0, v32
    v_fma_f32 v32, v86, 0, v32
    v_fma_f32 v32, v87, 0, v32
    v_fma_f32 v32, v96, 0, v32
    v_fma_f32 v32, v97, 0, v32
    v_fma_f32 v32, v98, 0, v32
    v_fma_f32 v32, v99, 0, v32
    v_fma_f32 v32, v100, 0, v32
    v_fma_f32 v32, v101, 0, v32
    v_fma_f32 v32, v102, 0, v32
    v_fma_f32 v32, v103, 0, v32
    v_mov_b32 v33, 0x5d800000
    v_add_f32 v32, v32, v88
    v_add_f32 v32, v32, v104
    v_cmp_nlt_f32 vcc, v32, v33
    s_cmp_lg_u32 s56, 0
    s_cbranch_scc1 L_k2_comb
    s_cmp_eq_u64 vcc, 0
    s_cbranch_scc1 L_k2_comb
    s_mov_b32 s56, 1
    s_mov_b32 s55, 0
    v_mov_b32 v120, v165
    v_mov_b32 v16, 0xff800000
    v_mov_b32 v17, 0xff800000
    v_mov_b32 v144, 0xff800000
    v_mov_b32 v145, 0xff800000
L_k2_mloop:
    ds_read_b128 v[112:115], v120
    s_waitcnt lgkmcnt(0)
    v_mfma_f32_32x32x16_bf16 v[32:47], v[112:115], v[8:11], 0
    v_mfma_f32_32x32x16_bf16 v[48:63], v[112:115], v[12:15], 0
    v_add_u32 v120, 1024, v120
    s_nop 7
    s_nop 3
    v_max3_f32 v16, v16, v32, v33
    v_max3_f32 v17, v17, v34, v35
    v_max3_f32 v16, v16, v36, v37
    v_max3_f32 v17, v17, v38, v39
    v_max3_f32 v16, v16, v40, v41
    v_max3_f32 v17, v17, v42, v43
    v_max3_f32 v16, v16, v44, v45
    v_max3_f32 v17, v17, v46, v47
    v_max3_f32 v144, v144, v48, v49
    v_max3_f32 v145, v145, v50, v51
    v_max3_f32 v144, v144, v52, v53
    v_max3_f32 v145, v145, v54, v55
    v_max3_f32 v144, v144, v56, v57
    v_max3_f32 v145, v145, v58, v59
    v_max3_f32 v144, v144, v60, v61
    v_max3_f32 v145, v145, v62, v63
    s_add_u32 s55, s55, 1
    s_cmp_lt_u32 s55, 32
    s_cbranch_scc1 L_k2_mloop
    s_branch L_k2_setmax
L_k2_comb:
    v_mov_b32 v105, v144
    s_mul_i32 s51, s45, 3072
    s_add_u32 s51, s51, 136704
    v_add_u32 v3, s51, v2
    s_xor_b32 s51, s45, 4
    s_mul_i32 s51, s51, 3072
    s_add_u32 s51, s51, 136704
    v_add_u32 v7, s51, v2
    v_mov_b32 v5, 162104
    s_mov_b32 s51, 20000
L_k2_lwhd:
    ds_read_b32 v6, v5
    s_waitcnt lgkmcnt(0)
    v_readfirstlane_b32 s52, v6
    s_cmp_ge_u32 s52, 4
    s_cbranch_scc1 L_k2_lwhd_go
    s_sleep 1
    s_sub_u32 s51, s51, 1
    s_cmp_lg_u32 s51, 0
    s_cbranch_scc1 L_k2_lwhd
L_k2_lwhd_go:
    ds_write_b128 v3, v[96:99]
    ds_write_b128 v3, v[100:103] offset:1024
    ds_write_b128 v3, v[104:107] offset:2048
    s_lshl_b32 s51, s45, 2
    s_add_u32 s51, s51, 162048
    v_mov_b32 v5, s51
    v_mov_b32 v6, 1
    s_waitcnt lgkmcnt(0)
    ds_write_b32 v5, v6
    v_xor_b32 v5, 16, v5
    v_mov_b32 v3, v7
    s_mov_b32 s51, 20000
L_k2_lwpr:
    ds_read_b32 v6, v5
    s_waitcnt lgkmcnt(0)
    v_readfirstlane_b32 s52, v6
    s_cmp_ge_u32 s52, 1
    s_cbranch_scc1 L_k2_lwpr_go
    s_sleep 1
    s_sub_u32 s51, s51, 1
    s_cmp_lg_u32 s51, 0
    s_cbranch_scc1 L_k2_lwpr
L_k2_lwpr_go:
    ds_read_b128 v[96:99], v3
    ds_read_b128 v[100:103], v3 offset:1024
    ds_read_b128 v[104:107], v3 offset:2048
    s_lshl_b32 s49, s48, 5
    s_add_u32 s49, s49, s40
    s_lshl_b32 s50, s49, 2
    s_add_u32 s50, s50, 29368320
    s_lshl_b32 s49, s49, 10
    s_add_u32 s49, s49, 8388608
    s_waitcnt lgkmcnt(0)
    v_mov_b32 v5, 162100
    v_mov_b32 v6, 1
    s_mov_b64 exec, 1
    ds_add_u32 v5, v6
    s_mov_b64 exec, -1
    v_min_f32 v32, v16, v105
    v_sub_f32 v33, v32, v16
    v_sub_f32 v34, v32, v105
    v_exp_f32 v33, v33
    v_exp_f32 v34, v34
    s_nop 0
    v_mul_f32 v88, v88, v33
    v_fmac_f32 v88, v104, v34
    v_rcp_f32 v88, v88
    s_nop 0
    v_mul_f32 v33, v33, v88
    v_mul_f32 v34, v34, v88
    v_mul_f32 v80, v80, v33
    v_mul_f32 v81, v81, v33
    v_mul_f32 v82, v82, v33
    v_mul_f32 v83, v83, v33
    v_mul_f32 v84, v84, v33
    v_mul_f32 v85, v85, v33
    v_mul_f32 v86, v86, v33
    v_mul_f32 v87, v87, v33
    v_fmac_f32 v80, v96, v34
    v_fmac_f32 v81, v97, v34
    v_fmac_f32 v82, v98, v34
    v_fmac_f32 v83, v99, v34
    v_fmac_f32 v84, v100, v34
    v_fmac_f32 v85, v101, v34
    v_fmac_f32 v86, v102, v34
    v_fmac_f32 v87, v103, v34
    v_cvt_pk_bf16_f32 v64, v80, v81
    v_cvt_pk_bf16_f32 v65, v82, v83
    v_cvt_pk_bf16_f32 v66, v84, v85
    v_cvt_pk_bf16_f32 v67, v86, v87
    buffer_store_dwordx4 v[64:67], v2, s[32:35], s49 offen sc1
    v_mov_b32 v5, 0
    v_mov_b32 v6, 1
    s_waitcnt vmcnt(0)
    s_mov_b64 exec, 1
    buffer_store_dword v6, v5, s[32:35], s50 offen sc1
    s_mov_b64 exec, -1
    s_endpgm
L_k2_b:
    s_sub_u32 s45, s44, 8
    s_mov_b32 s24, s4
    s_and_b32 s25, s5, 0xffff
    s_mov_b32 s26, 2097152
    s_mov_b32 s27, 0x00020000
    s_mov_b32 s28, s6
    s_and_b32 s29, s7, 0xffff
    s_mov_b32 s30, 2097152
    s_mov_b32 s31, 0x00020000
    s_lshl_b32 s46, s40, 16
    s_lshl_b32 s47, s45, 10
    s_add_u32 s46, s46, s47
    s_add_u32 s46, s46, 2097152
    s_add_u32 m0, s47, 0
    s_add_u32 s48, s46, 0
    buffer_load_dwordx4 v2, s[32:35], s48 offen lds
    s_add_u32 m0, s47, 65536
    s_add_u32 s48, s46, 2097152
    buffer_load_dwordx4 v2, s[32:35], s48 offen lds
    s_add_u32 m0, s47, 4096
    s_add_u32 s48, s46, 4096
    buffer_load_dwordx4 v2, s[32:35], s48 offen lds
    s_add_u32 m0, s47, 69632
    s_add_u32 s48, s46, 2101248
    buffer_load_dwordx4 v2, s[32:35], s48 offen lds
    s_add_u32 m0, s47, 32768
    s_add_u32 s48, s46, 32768
    buffer_load_dwordx4 v2, s[32:35], s48 offen lds
    s_add_u32 m0, s47, 98304
    s_add_u32 s48, s46, 2129920
    buffer_load_dwordx4 v2, s[32:35], s48 offen lds
    s_add_u32 m0, s47, 36864
    s_add_u32 s48, s46, 36864
    buffer_load_dwordx4 v2, s[32:35], s48 offen lds
    s_add_u32 m0, s47, 102400
    s_add_u32 s48, s46, 2134016
    buffer_load_dwordx4 v2, s[32:35], s48 offen lds
    s_add_u32 m0, s47, 8192
    s_add_u32 s48, s46, 8192
    buffer_load_dwordx4 v2, s[32:35], s48 offen lds
    s_add_u32 m0, s47, 73728
    s_add_u32 s48, s46, 2105344
    buffer_load_dwordx4 v2, s[32:35], s48 offen lds
    s_add_u32 m0, s47, 12288
    s_add_u32 s48, s46, 12288
    buffer_load_dwordx4 v2, s[32:35], s48 offen lds
    s_add_u32 m0, s47, 77824
    s_add_u32 s48, s46, 2109440
    buffer_load_dwordx4 v2, s[32:35], s48 offen lds
    s_add_u32 m0, s47, 40960
    s_add_u32 s48, s46, 40960
    buffer_load_dwordx4 v2, s[32:35], s48 offen lds
    s_add_u32 m0, s47, 106496
    s_add_u32 s48, s46, 2138112
    buffer_load_dwordx4 v2, s[32:35], s48 offen lds
    s_add_u32 m0, s47, 45056
    s_add_u32 s48, s46, 45056
    buffer_load_dwordx4 v2, s[32:35], s48 offen lds
    s_add_u32 m0, s47, 110592
    s_add_u32 s48, s46, 2142208
    buffer_load_dwordx4 v2, s[32:35], s48 offen lds
    s_waitcnt vmcnt(8)
    v_mov_b32 v6, 162084
    v_mov_b32 v7, 1
    s_mov_b64 exec, 1
    ds_add_u32 v6, v7
    s_mov_b64 exec, -1
    s_setprio 3
    s_and_b32 s50, s45, 1
    s_lshr_b32 s51, s45, 1
    s_lshl_b32 s64, s40, 1
    s_add_u32 s64, s64, s50
    s_lshl_b32 s65, s41, 1
    s_add_u32 s65, s65, s51
    s_xor_b32 s60, s45, 1
    s_mul_i32 s60, s60, 6144
    s_add_u32 s60, s60, 136704
    v_add_u32 v3, s60, v2
    s_xor_b32 s60, s45, 2
    s_mul_i32 s60, s60, 6144
    s_add_u32 s60, s60, 138752
    v_add_u32 v4, s60, v2
    s_xor_b32 s60, s45, 3
    s_mul_i32 s60, s60, 6144
    s_add_u32 s60, s60, 140800
    v_add_u32 v5, s60, v2
    s_mul_i32 s52, s45, 6144
    s_add_u32 s52, s52, 136704
    s_lshl_b32 s60, s64, 15
    s_lshl_b32 s61, s65, 6
    s_add_u32 s60, s60, s61
    v_and_b32 v146, 31, v1
    v_lshrrev_b32 v147, 5, v1
    v_lshlrev_b32 v148, 10, v146
    v_lshl_add_u32 v148, v147, 3, v148
    buffer_load_dwordx2 v[136:137], v148, s[24:27], s60 offen offset:0
    buffer_load_dwordx2 v[138:139], v148, s[24:27], s60 offen offset:16
    buffer_load_dwordx2 v[140:141], v148, s[24:27], s60 offen offset:32
    buffer_load_dwordx2 v[142:143], v148, s[24:27], s60 offen offset:48
    s_lshl_b32 s61, s64, 8
    s_add_u32 s61, s61, 23068672
    v_lshlrev_b32 v148, 3, v146
    buffer_load_dwordx2 v[144:145], v148, s[32:35], s61 offen
    s_lshl_b32 s60, s45, 3
    s_lshl_b32 s56, s64, 5
    s_add_u32 s56, s56, s60
    s_lshl_b32 s56, s56, 10
    s_add_u32 s56, s56, 6291456
    s_lshl_b32 s57, s65, 5
    s_add_u32 s57, s57, s60
    s_lshl_b32 s57, s57, 10
    s_add_u32 s57, s57, 18874368
    s_mov_b32 s53, 32768
    s_cmp_eq_u32 s50, 1
    s_cselect_b32 s53, 4294934528, s53
    s_mov_b32 s54, 32768
    s_cmp_eq_u32 s51, 1
    s_cselect_b32 s54, 4294934528, s54
    buffer_load_dwordx4 v[72:75], v2, s[32:35], s56 offen
    s_add_u32 s62, s56, s53
    buffer_load_dwordx4 v[76:79], v2, s[32:35], s62 offen
    buffer_load_dwordx4 v[80:83], v2, s[32:35], s57 offen
    s_add_u32 s62, s57, s54
    buffer_load_dwordx4 v[84:87], v2, s[32:35], s62 offen
    s_add_u32 s56, s56, 1024
    s_add_u32 s57, s57, 1024
    buffer_load_dwordx4 v[88:91], v2, s[32:35], s56 offen
    s_add_u32 s62, s56, s53
    buffer_load_dwordx4 v[92:95], v2, s[32:35], s62 offen
    buffer_load_dwordx4 v[96:99], v2, s[32:35], s57 offen
    s_add_u32 s62, s57, s54
    buffer_load_dwordx4 v[100:103], v2, s[32:35], s62 offen
    s_add_u32 s56, s56, 1024
    s_add_u32 s57, s57, 1024
    buffer_load_dwordx4 v[104:107], v2, s[32:35], s56 offen
    s_add_u32 s62, s56, s53
    buffer_load_dwordx4 v[108:111], v2, s[32:35], s62 offen
    buffer_load_dwordx4 v[112:115], v2, s[32:35], s57 offen
    s_add_u32 s62, s57, s54
    buffer_load_dwordx4 v[116:119], v2, s[32:35], s62 offen
    s_add_u32 s56, s56, 1024
    s_add_u32 s57, s57, 1024
    buffer_load_dwordx4 v[120:123], v2, s[32:35], s56 offen
    s_add_u32 s62, s56, s53
    buffer_load_dwordx4 v[124:127], v2, s[32:35], s62 offen
    buffer_load_dwordx4 v[128:131], v2, s[32:35], s57 offen
    s_add_u32 s62, s57, s54
    buffer_load_dwordx4 v[132:135], v2, s[32:35], s62 offen
    s_add_u32 s56, s56, 1024
    s_add_u32 s57, s57, 1024
    s_waitcnt vmcnt(21)
    v_mov_b32 v6, 162088
    v_mov_b32 v7, 1
    s_mov_b64 exec, 1
    ds_add_u32 v6, v7
    s_mov_b64 exec, -1
    v_mov_b32 v6, 162092
    v_mov_b32 v7, 1
    s_mov_b64 exec, 1
    ds_add_u32 v6, v7
    s_mov_b64 exec, -1
    s_waitcnt vmcnt(12)
    s_setprio 0
    v_mfma_f32_32x32x16_bf16 v[8:23], v[80:83], v[72:75], 0
    v_mfma_f32_32x32x16_bf16 v[24:39], v[80:83], v[76:79], 0
    buffer_load_dwordx4 v[80:83], v2, s[32:35], s57 offen
    v_mfma_f32_32x32x16_bf16 v[40:55], v[84:87], v[72:75], 0
    buffer_load_dwordx4 v[72:75], v2, s[32:35], s56 offen
    v_mfma_f32_32x32x16_bf16 v[56:71], v[84:87], v[76:79], 0
    s_add_u32 s62, s57, s54
    buffer_load_dwordx4 v[84:87], v2, s[32:35], s62 offen
    s_add_u32 s62, s56, s53
    buffer_load_dwordx4 v[76:79], v2, s[32:35], s62 offen
    s_setprio 3
    s_add_u32 s56, s56, 1024
    s_add_u32 s57, s57, 1024
    s_waitcnt vmcnt(12)
    s_setprio 0
    v_mfma_f32_32x32x16_bf16 v[8:23], v[96:99], v[88:91], v[8:23]
    v_mfma_f32_32x32x16_bf16 v[24:39], v[96:99], v[92:95], v[24:39]
    buffer_load_dwordx4 v[96:99], v2, s[32:35], s57 offen
    v_mfma_f32_32x32x16_bf16 v[40:55], v[100:103], v[88:91], v[40:55]
    buffer_load_dwordx4 v[88:91], v2, s[32:35], s56 offen
    v_mfma_f32_32x32x16_bf16 v[56:71], v[100:103], v[92:95], v[56:71]
    s_add_u32 s62, s57, s54
    buffer_load_dwordx4 v[100:103], v2, s[32:35], s62 offen
    s_add_u32 s62, s56, s53
    buffer_load_dwordx4 v[92:95], v2, s[32:35], s62 offen
    s_setprio 3
    s_add_u32 s56, s56, 1024
    s_add_u32 s57, s57, 1024
    s_waitcnt vmcnt(12)
    s_setprio 0
    v_mfma_f32_32x32x16_bf16 v[8:23], v[112:115], v[104:107], v[8:23]
    v_mfma_f32_32x32x16_bf16 v[24:39], v[112:115], v[108:111], v[24:39]
    buffer_load_dwordx4 v[112:115], v2, s[32:35], s57 offen
    v_mfma_f32_32x32x16_bf16 v[40:55], v[116:119], v[104:107], v[40:55]
    buffer_load_dwordx4 v[104:107], v2, s[32:35], s56 offen
    v_mfma_f32_32x32x16_bf16 v[56:71], v[116:119], v[108:111], v[56:71]
    s_add_u32 s62, s57, s54
    buffer_load_dwordx4 v[116:119], v2, s[32:35], s62 offen
    s_add_u32 s62, s56, s53
    buffer_load_dwordx4 v[108:111], v2, s[32:35], s62 offen
    s_setprio 3
    s_add_u32 s56, s56, 1024
    s_add_u32 s57, s57, 1024
    s_waitcnt vmcnt(12)
    s_setprio 0
    v_mfma_f32_32x32x16_bf16 v[8:23], v[128:131], v[120:123], v[8:23]
    v_mfma_f32_32x32x16_bf16 v[24:39], v[128:131], v[124:127], v[24:39]
    buffer_load_dwordx4 v[128:131], v2, s[32:35], s57 offen
    v_mfma_f32_32x32x16_bf16 v[40:55], v[132:135], v[120:123], v[40:55]
    buffer_load_dwordx4 v[120:123], v2, s[32:35], s56 offen
    v_mfma_f32_32x32x16_bf16 v[56:71], v[132:135], v[124:127], v[56:71]
    s_add_u32 s62, s57, s54
    buffer_load_dwordx4 v[132:135], v2, s[32:35], s62 offen
    s_add_u32 s62, s56, s53
    buffer_load_dwordx4 v[124:127], v2, s[32:35], s62 offen
    s_setprio 3
    s_add_u32 s56, s56, 1024
    s_add_u32 s57, s57, 1024
    s_waitcnt vmcnt(12)
    s_setprio 0
    v_mfma_f32_32x32x16_bf16 v[8:23], v[80:83], v[72:75], v[8:23]
    v_mfma_f32_32x32x16_bf16 v[24:39], v[80:83], v[76:79], v[24:39]
    v_mfma_f32_32x32x16_bf16 v[40:55], v[84:87], v[72:75], v[40:55]
    v_mfma_f32_32x32x16_bf16 v[56:71], v[84:87], v[76:79], v[56:71]
    s_setprio 3
    s_waitcnt vmcnt(8)
    s_setprio 0
    v_mfma_f32_32x32x16_bf16 v[8:23], v[96:99], v[88:91], v[8:23]
    v_mfma_f32_32x32x16_bf16 v[24:39], v[96:99], v[92:95], v[24:39]
    v_mfma_f32_32x32x16_bf16 v[40:55], v[100:103], v[88:91], v[40:55]
    v_mfma_f32_32x32x16_bf16 v[56:71], v[100:103], v[92:95], v[56:71]
    s_setprio 3
    s_waitcnt vmcnt(4)
    s_setprio 0
    v_mfma_f32_32x32x16_bf16 v[8:23], v[112:115], v[104:107], v[8:23]
    v_mfma_f32_32x32x16_bf16 v[24:39], v[112:115], v[108:111], v[24:39]
    v_mfma_f32_32x32x16_bf16 v[40:55], v[116:119], v[104:107], v[40:55]
    v_mfma_f32_32x32x16_bf16 v[56:71], v[116:119], v[108:111], v[56:71]
    s_setprio 3
    s_waitcnt vmcnt(0)
    s_setprio 0
    v_mfma_f32_32x32x16_bf16 v[8:23], v[128:131], v[120:123], v[8:23]
    v_mfma_f32_32x32x16_bf16 v[24:39], v[128:131], v[124:127], v[24:39]
    v_mfma_f32_32x32x16_bf16 v[40:55], v[132:135], v[120:123], v[40:55]
    v_mfma_f32_32x32x16_bf16 v[56:71], v[132:135], v[124:127], v[56:71]
    s_setprio 3
    s_mul_i32 s66, s41, 5
    s_min_u32 s60, s41, 3
    s_add_u32 s66, s66, s60
    s_and_b32 s61, s40, 3
    s_lshl_b32 s61, s61, 2
    s_add_u32 s61, s61, s45
    s_lshl_b32 s62, s66, 5
    s_mul_i32 s63, s61, 12
    s_add_u32 s62, s62, s63
    s_lshl_b32 s62, s62, 10
    s_add_u32 s62, s62, 19922944
    v_lshlrev_b32 v6, 7, v1
    buffer_load_dword v149, v6, s[32:35], s62 offen
    s_add_u32 s62, s62, 4096
    buffer_load_dword v149, v6, s[32:35], s62 offen
    s_nop 7
    s_nop 3
    v_add_u32 v96, s52, v2
    ds_write_b128 v3, v[24:27] offset:0
    ds_write_b128 v3, v[28:31] offset:1024
    ds_write_b128 v4, v[40:43] offset:0
    ds_write_b128 v4, v[44:47] offset:1024
    ds_write_b128 v5, v[56:59] offset:0
    ds_write_b128 v5, v[60:63] offset:1024
    s_waitcnt lgkmcnt(0)
    v_mov_b32 v6, 162080
    v_mov_b32 v7, 1
    s_mov_b64 exec, 1
    ds_add_u32 v6, v7
    s_mov_b64 exec, -1
    s_mov_b32 s68, 20000
L_k2_lwsy1:
    ds_read_b32 v7, v6
    s_waitcnt lgkmcnt(0)
    v_readfirstlane_b32 s69, v7
    s_cmp_ge_u32 s69, 4
    s_cbranch_scc1 L_k2_lwsy1_go
    s_sleep 1
    s_sub_u32 s68, s68, 1
    s_cmp_lg_u32 s68, 0
    s_cbranch_scc1 L_k2_lwsy1
L_k2_lwsy1_go:
    ds_read_b128 v[72:75], v96 offset:0
    ds_read_b128 v[76:79], v96 offset:1024
    ds_read_b128 v[80:83], v96 offset:2048
    ds_read_b128 v[84:87], v96 offset:3072
    ds_read_b128 v[88:91], v96 offset:4096
    ds_read_b128 v[92:95], v96 offset:5120
    s_waitcnt lgkmcnt(0)
    v_mov_b32 v6, 162080
    v_mov_b32 v7, 1
    s_mov_b64 exec, 1
    ds_add_u32 v6, v7
    s_mov_b64 exec, -1
    s_mov_b32 s68, 20000
L_k2_lwsy2:
    ds_read_b32 v7, v6
    s_waitcnt lgkmcnt(0)
    v_readfirstlane_b32 s69, v7
    s_cmp_ge_u32 s69, 8
    s_cbranch_scc1 L_k2_lwsy2_go
    s_sleep 1
    s_sub_u32 s68, s68, 1
    s_cmp_lg_u32 s68, 0
    s_cbranch_scc1 L_k2_lwsy2
L_k2_lwsy2_go:
    v_add_f32 v8, v8, v72
    v_add_f32 v9, v9, v73
    v_add_f32 v10, v10, v74
    v_add_f32 v11, v11, v75
    v_add_f32 v12, v12, v76
    v_add_f32 v13, v13, v77
    v_add_f32 v14, v14, v78
    v_add_f32 v15, v15, v79
    v_add_f32 v8, v8, v80
    v_add_f32 v9, v9, v81
    v_add_f32 v10, v10, v82
    v_add_f32 v11, v11, v83
    v_add_f32 v12, v12, v84
    v_add_f32 v13, v13, v85
    v_add_f32 v14, v14, v86
    v_add_f32 v15, v15, v87
    v_add_f32 v8, v8, v88
    v_add_f32 v9, v9, v89
    v_add_f32 v10, v10, v90
    v_add_f32 v11, v11, v91
    v_add_f32 v12, v12, v92
    v_add_f32 v13, v13, v93
    v_add_f32 v14, v14, v94
    v_add_f32 v15, v15, v95
    ds_write_b128 v3, v[32:35] offset:0
    ds_write_b128 v3, v[36:39] offset:1024
    ds_write_b128 v4, v[48:51] offset:0
    ds_write_b128 v4, v[52:55] offset:1024
    ds_write_b128 v5, v[64:67] offset:0
    ds_write_b128 v5, v[68:71] offset:1024
    s_waitcnt lgkmcnt(0)
    v_mov_b32 v6, 162080
    v_mov_b32 v7, 1
    s_mov_b64 exec, 1
    ds_add_u32 v6, v7
    s_mov_b64 exec, -1
    s_mov_b32 s68, 20000
L_k2_lwsy3:
    ds_read_b32 v7, v6
    s_waitcnt lgkmcnt(0)
    v_readfirstlane_b32 s69, v7
    s_cmp_ge_u32 s69, 12
    s_cbranch_scc1 L_k2_lwsy3_go
    s_sleep 1
    s_sub_u32 s68, s68, 1
    s_cmp_lg_u32 s68, 0
    s_cbranch_scc1 L_k2_lwsy3
L_k2_lwsy3_go:
    ds_read_b128 v[72:75], v96 offset:0
    ds_read_b128 v[76:79], v96 offset:1024
    ds_read_b128 v[80:83], v96 offset:2048
    ds_read_b128 v[84:87], v96 offset:3072
    ds_read_b128 v[88:91], v96 offset:4096
    ds_read_b128 v[92:95], v96 offset:5120
    s_waitcnt lgkmcnt(0)
    v_add_f32 v16, v16, v72
    v_add_f32 v17, v17, v73
    v_add_f32 v18, v18, v74
    v_add_f32 v19, v19, v75
    v_add_f32 v20, v20, v76
    v_add_f32 v21, v21, v77
    v_add_f32 v22, v22, v78
    v_add_f32 v23, v23, v79
    v_add_f32 v16, v16, v80
    v_add_f32 v17, v17, v81
    v_add_f32 v18, v18, v82
    v_add_f32 v19, v19, v83
    v_add_f32 v20, v20, v84
    v_add_f32 v21, v21, v85
    v_add_f32 v22, v22, v86
    v_add_f32 v23, v23, v87
    v_add_f32 v16, v16, v88
    v_add_f32 v17, v17, v89
    v_add_f32 v18, v18, v90
    v_add_f32 v19, v19, v91
    v_add_f32 v20, v20, v92
    v_add_f32 v21, v21, v93
    v_add_f32 v22, v22, v94
    v_add_f32 v23, v23, v95
    v_mul_f32 v146, v144, v145
    s_mov_b32 s60, 0xffff0000
    v_lshlrev_b32 v72, 16, v136
    v_and_b32 v73, s60, v136
    v_lshlrev_b32 v74, 16, v137
    v_and_b32 v75, s60, v137
    v_lshlrev_b32 v76, 16, v138
    v_and_b32 v77, s60, v138
    v_lshlrev_b32 v78, 16, v139
    v_and_b32 v79, s60, v139
    v_lshlrev_b32 v80, 16, v140
    v_and_b32 v81, s60, v140
    v_lshlrev_b32 v82, 16, v141
    v_and_b32 v83, s60, v141
    v_lshlrev_b32 v84, 16, v142
    v_and_b32 v85, s60, v142
    v_lshlrev_b32 v86, 16, v143
    v_and_b32 v87, s60, v143
    v_sub_f32 v8, v8, v146
    v_sub_f32 v9, v9, v146
    v_sub_f32 v10, v10, v146
    v_sub_f32 v11, v11, v146
    v_sub_f32 v12, v12, v146
    v_sub_f32 v13, v13, v146
    v_sub_f32 v14, v14, v146
    v_sub_f32 v15, v15, v146
    v_sub_f32 v16, v16, v146
    v_sub_f32 v17, v17, v146
    v_sub_f32 v18, v18, v146
    v_sub_f32 v19, v19, v146
    v_sub_f32 v20, v20, v146
    v_sub_f32 v21, v21, v146
    v_sub_f32 v22, v22, v146
    v_sub_f32 v23, v23, v146
    v_fmac_f32 v8, v72, v145
    v_fmac_f32 v9, v73, v145
    v_fmac_f32 v10, v74, v145
    v_fmac_f32 v11, v75, v145
    v_fmac_f32 v12, v76, v145
    v_fmac_f32 v13, v77, v145
    v_fmac_f32 v14, v78, v145
    v_fmac_f32 v15, v79, v145
    v_fmac_f32 v16, v80, v145
    v_fmac_f32 v17, v81, v145
    v_fmac_f32 v18, v82, v145
    v_fmac_f32 v19, v83, v145
    v_fmac_f32 v20, v84, v145
    v_fmac_f32 v21, v85, v145
    v_fmac_f32 v22, v86, v145
    v_fmac_f32 v23, v87, v145
    v_cvt_pk_bf16_f32 v24, v8, v9
    v_cvt_pk_bf16_f32 v25, v10, v11
    v_cvt_pk_bf16_f32 v26, v12, v13
    v_cvt_pk_bf16_f32 v27, v14, v15
    v_cvt_pk_bf16_f32 v28, v16, v17
    v_cvt_pk_bf16_f32 v29, v18, v19
    v_cvt_pk_bf16_f32 v30, v20, v21
    v_cvt_pk_bf16_f32 v31, v22, v23
    s_lshl_b32 s60, s64, 5
    s_lshl_b32 s61, s65, 1
    s_add_u32 s60, s60, s61
    s_lshl_b32 s60, s60, 10
    s_add_u32 s60, s60, 10485760
    buffer_store_dwordx4 v[24:27], v2, s[32:35], s60 offen sc1
    buffer_store_dwordx4 v[28:31], v2, s[32:35], s60 offen offset:1024 sc1
    v_add_f32 v144, v8, v9
    v_mul_f32 v145, v8, v8
    v_add_f32 v146, v10, v11
    v_mul_f32 v147, v9, v9
    v_fmac_f32 v145, v10, v10
    v_fmac_f32 v147, v11, v11
    v_add_f32 v144, v144, v12
    v_fmac_f32 v145, v12, v12
    v_add_f32 v146, v146, v13
    v_fmac_f32 v147, v13, v13
    v_add_f32 v144, v144, v14
    v_fmac_f32 v145, v14, v14
    v_add_f32 v146, v146, v15
    v_fmac_f32 v147, v15, v15
    v_add_f32 v144, v144, v16
    v_fmac_f32 v145, v16, v16
    v_add_f32 v146, v146, v17
    v_fmac_f32 v147, v17, v17
    v_add_f32 v144, v144, v18
    v_fmac_f32 v145, v18, v18
    v_add_f32 v146, v146, v19
    v_fmac_f32 v147, v19, v19
    v_add_f32 v144, v144, v20
    v_fmac_f32 v145, v20, v20
    v_add_f32 v146, v146, v21
    v_fmac_f32 v147, v21, v21
    v_add_f32 v144, v144, v22
    v_fmac_f32 v145, v22, v22
    v_add_f32 v146, v146, v23
    v_fmac_f32 v147, v23, v23
    v_add_f32 v144, v144, v146
    v_add_f32 v145, v145, v147
    v_mov_b32 v146, v144
    v_mov_b32 v147, v145
    s_lshl_b32 s60, s64, 4
    s_add_u32 s60, s60, s65
    v_permlane32_swap_b32 v144, v146
    v_permlane32_swap_b32 v145, v147
    s_lshl_b32 s60, s60, 8
    s_add_u32 s60, s60, 23592960
    v_add_f32 v144, v144, v146
    v_add_f32 v145, v145, v147
    s_mov_b32 exec_hi, 0
    buffer_store_dwordx2 v[144:145], v148, s[32:35], s60 offen sc1
    s_mov_b64 exec, -1
    s_waitcnt vmcnt(0)
    s_lshl_b32 s70, s40, 8
    s_add_u32 s70, s70, 29360128
    s_lshl_b32 s61, s41, 2
    s_add_u32 s61, s61, s45
    s_lshl_b32 s61, s61, 2
    v_mov_b32 v6, s61
    v_mov_b32 v7, 1
    s_mov_b64 exec, 1
    buffer_store_dword v7, v6, s[32:35], s70 offen sc1
    s_mov_b64 exec, -1
    s_add_u32 m0, s47, 16384
    s_add_u32 s48, s46, 16384
    buffer_load_dwordx4 v2, s[32:35], s48 offen lds
    s_add_u32 m0, s47, 81920
    s_add_u32 s48, s46, 2113536
    buffer_load_dwordx4 v2, s[32:35], s48 offen lds
    s_add_u32 m0, s47, 20480
    s_add_u32 s48, s46, 20480
    buffer_load_dwordx4 v2, s[32:35], s48 offen lds
    s_add_u32 m0, s47, 86016
    s_add_u32 s48, s46, 2117632
    buffer_load_dwordx4 v2, s[32:35], s48 offen lds
    s_add_u32 m0, s47, 24576
    s_add_u32 s48, s46, 24576
    buffer_load_dwordx4 v2, s[32:35], s48 offen lds
    s_add_u32 m0, s47, 90112
    s_add_u32 s48, s46, 2121728
    buffer_load_dwordx4 v2, s[32:35], s48 offen lds
    s_add_u32 m0, s47, 28672
    s_add_u32 s48, s46, 28672
    buffer_load_dwordx4 v2, s[32:35], s48 offen lds
    s_add_u32 m0, s47, 94208
    s_add_u32 s48, s46, 2125824
    buffer_load_dwordx4 v2, s[32:35], s48 offen lds
    s_add_u32 m0, s47, 49152
    s_add_u32 s48, s46, 49152
    buffer_load_dwordx4 v2, s[32:35], s48 offen lds
    s_add_u32 m0, s47, 114688
    s_add_u32 s48, s46, 2146304
    buffer_load_dwordx4 v2, s[32:35], s48 offen lds
    s_add_u32 m0, s47, 53248
    s_add_u32 s48, s46, 53248
    buffer_load_dwordx4 v2, s[32:35], s48 offen lds
    s_add_u32 m0, s47, 118784
    s_add_u32 s48, s46, 2150400
    buffer_load_dwordx4 v2, s[32:35], s48 offen lds
    s_add_u32 m0, s47, 57344
    s_add_u32 s48, s46, 57344
    buffer_load_dwordx4 v2, s[32:35], s48 offen lds
    s_add_u32 m0, s47, 122880
    s_add_u32 s48, s46, 2154496
    buffer_load_dwordx4 v2, s[32:35], s48 offen lds
    s_add_u32 m0, s47, 61440
    s_add_u32 s48, s46, 61440
    buffer_load_dwordx4 v2, s[32:35], s48 offen lds
    s_add_u32 m0, s47, 126976
    s_add_u32 s48, s46, 2158592
    buffer_load_dwordx4 v2, s[32:35], s48 offen lds
    s_mul_i32 s60, s45, 192
    s_lshl_b32 s61, s66, 7
    s_add_u32 s60, s60, s61
    s_add_u32 s60, s60, 29425664
    v_lshrrev_b32 v40, 4, v1
    v_mul_u32_u24 v40, 45056, v40
    v_and_b32 v41, 15, v1
    v_lshl_add_u32 v40, v41, 4, v40
    buffer_load_dwordx4 v[8:11], v40, s[32:35], s60 offen
    s_add_u32 s60, s60, 1408*4
    buffer_load_dwordx4 v[12:15], v40, s[32:35], s60 offen
    s_add_u32 s60, s60, 1408*4
    buffer_load_dwordx4 v[16:19], v40, s[32:35], s60 offen
    s_add_u32 s60, s60, 1408*4
    buffer_load_dwordx4 v[20:23], v40, s[32:35], s60 offen
    s_add_u32 s60, s60, 1408*4
    buffer_load_dwordx4 v[24:27], v40, s[32:35], s60 offen
    s_add_u32 s60, s60, 1408*4
    buffer_load_dwordx4 v[28:31], v40, s[32:35], s60 offen
    s_add_u32 s60, s60, 1408*4
    buffer_load_dwordx4 v[32:35], v40, s[32:35], s60 offen
    s_add_u32 s60, s60, 1408*4
    buffer_load_dwordx4 v[36:39], v40, s[32:35], s60 offen
    s_mul_i32 s60, s45, 192
    s_add_u32 s60, s60, 161280
    v_add_u32 v6, s60, v2
    s_waitcnt vmcnt(0)
    v_add_f32 v8, v8, v12
    v_add_f32 v9, v9, v13
    v_add_f32 v10, v10, v14
    v_add_f32 v11, v11, v15
    v_add_f32 v8, v8, v16
    v_add_f32 v9, v9, v17
    v_add_f32 v10, v10, v18
    v_add_f32 v11, v11, v19
    v_add_f32 v8, v8, v20
    v_add_f32 v9, v9, v21
    v_add_f32 v10, v10, v22
    v_add_f32 v11, v11, v23
    v_add_f32 v8, v8, v24
    v_add_f32 v9, v9, v25
    v_add_f32 v10, v10, v26
    v_add_f32 v11, v11, v27
    v_add_f32 v8, v8, v28
    v_add_f32 v9, v9, v29
    v_add_f32 v10, v10, v30
    v_add_f32 v11, v11, v31
    v_add_f32 v8, v8, v32
    v_add_f32 v9, v9, v33
    v_add_f32 v10, v10, v34
    v_add_f32 v11, v11, v35
    v_add_f32 v8, v8, v36
    v_add_f32 v9, v9, v37
    v_add_f32 v10, v10, v38
    v_add_f32 v11, v11, v39
    v_mov_b32 v12, v8
    v_mov_b32 v13, v9
    v_mov_b32 v14, v10
    v_mov_b32 v15, v11
    s_nop 0
    v_permlane32_swap_b32 v8, v12
    v_permlane32_swap_b32 v9, v13
    v_permlane32_swap_b32 v10, v14
    v_permlane32_swap_b32 v11, v15
    v_add_f32 v8, v8, v12
    v_add_f32 v9, v9, v13
    v_add_f32 v10, v10, v14
    v_add_f32 v11, v11, v15
    v_mov_b32 v12, v8
    v_mov_b32 v13, v9
    v_mov_b32 v14, v10
    v_mov_b32 v15, v11
    s_nop 0
    v_permlane16_swap_b32 v8, v12
    v_permlane16_swap_b32 v9, v13
    v_permlane16_swap_b32 v10, v14
    v_permlane16_swap_b32 v11, v15
    v_add_f32 v8, v8, v12
    v_add_f32 v9, v9, v13
    v_add_f32 v10, v10, v14
    v_add_f32 v11, v11, v15
    s_mov_b64 exec, 0xfff
    ds_write_b128 v6, v[8:11]
    s_mov_b64 exec, -1
    v_mov_b32 v6, 162096
    v_mov_b32 v7, 1
    s_mov_b64 exec, 1
    ds_add_u32 v6, v7
    s_mov_b64 exec, -1
    s_mul_i32 s61, s51, 3
    s_add_u32 s67, s66, s61
    s_lshl_b32 s60, s50, 4
    s_lshl_b32 s56, s64, 5
    s_add_u32 s56, s56, s60
    s_lshl_b32 s56, s56, 10
    s_add_u32 s56, s56, 10485760
    s_lshl_b32 s57, s67, 5
    s_add_u32 s57, s57, s60
    s_lshl_b32 s57, s57, 10
    s_add_u32 s57, s57, 19922944
    v_and_b32 v6, 31, v1
    v_lshlrev_b32 v6, 2, v6
    s_mov_b32 s68, 20000
L_k2_xs0:
    buffer_load_dword v7, v6, s[32:35], s70 offen sc1
    s_waitcnt vmcnt(0)
    v_cmp_eq_u32 vcc, 0, v7
    s_cmp_eq_u64 vcc, 0
    s_cbranch_scc1 L_k2_xs0_go
    s_sleep 2
    s_sub_u32 s68, s68, 1
    s_cmp_lg_u32 s68, 0
    s_cbranch_scc1 L_k2_xs0
L_k2_xs0_go:
    buffer_load_dwordx4 v[104:107], v2, s[32:35], s56 offen sc1
    s_add_u32 s62, s56, s53
    buffer_load_dwordx4 v[108:111], v2, s[32:35], s62 offen sc1
    buffer_load_dwordx4 v[112:115], v2, s[32:35], s57 offen
    s_add_u32 s62, s57, 32768
    buffer_load_dwordx4 v[116:119], v2, s[32:35], s62 offen
    s_add_u32 s62, s57, 65536
    buffer_load_dwordx4 v[120:123], v2, s[32:35], s62 offen
    s_add_u32 s56, s56, 1024
    s_add_u32 s57, s57, 1024
    buffer_load_dwordx4 v[124:127], v2, s[32:35], s56 offen sc1
    s_add_u32 s62, s56, s53
    buffer_load_dwordx4 v[128:131], v2, s[32:35], s62 offen sc1
    buffer_load_dwordx4 v[132:135], v2, s[32:35], s57 offen
    s_add_u32 s62, s57, 32768
    buffer_load_dwordx4 v[136:139], v2, s[32:35], s62 offen
    s_add_u32 s62, s57, 65536
    buffer_load_dwordx4 v[140:143], v2, s[32:35], s62 offen
    s_add_u32 s56, s56, 1024
    s_add_u32 s57, s57, 1024
    buffer_load_dwordx4 v[144:147], v2, s[32:35], s56 offen sc1
    s_add_u32 s62, s56, s53
    buffer_load_dwordx4 v[148:151], v2, s[32:35], s62 offen sc1
    buffer_load_dwordx4 v[152:155], v2, s[32:35], s57 offen
    s_add_u32 s62, s57, 32768
    buffer_load_dwordx4 v[156:159], v2, s[32:35], s62 offen
    s_add_u32 s62, s57, 65536
    buffer_load_dwordx4 v[160:163], v2, s[32:35], s62 offen
    s_add_u32 s56, s56, 1024
    s_add_u32 s57, s57, 1024
    s_waitcnt vmcnt(10)
    s_setprio 0
    v_mfma_f32_32x32x16_bf16 v[8:23], v[112:115], v[104:107], 0
    v_mfma_f32_32x32x16_bf16 v[24:39], v[112:115], v[108:111], 0
    buffer_load_dwordx4 v[112:115], v2, s[32:35], s57 offen
    v_mfma_f32_32x32x16_bf16 v[40:55], v[116:119], v[104:107], 0
    v_mfma_f32_32x32x16_bf16 v[56:71], v[116:119], v[108:111], 0
    s_add_u32 s62, s57, 32768
    buffer_load_dwordx4 v[116:119], v2, s[32:35], s62 offen
    v_mfma_f32_32x32x16_bf16 v[72:87], v[120:123], v[104:107], 0
    buffer_load_dwordx4 v[104:107], v2, s[32:35], s56 offen sc1
    v_mfma_f32_32x32x16_bf16 v[88:103], v[120:123], v[108:111], 0
    s_add_u32 s62, s57, 65536
    buffer_load_dwordx4 v[120:123], v2, s[32:35], s62 offen
    s_add_u32 s62, s56, s53
    buffer_load_dwordx4 v[108:111], v2, s[32:35], s62 offen sc1
    s_setprio 3
    s_add_u32 s56, s56, 1024
    s_add_u32 s57, s57, 1024
    s_mov_b32 s58, 4
L_k2_w3_loop:
    s_waitcnt vmcnt(10)
    s_setprio 0
    v_mfma_f32_32x32x16_bf16 v[8:23], v[132:135], v[124:127], v[8:23]
    v_mfma_f32_32x32x16_bf16 v[24:39], v[132:135], v[128:131], v[24:39]
    buffer_load_dwordx4 v[132:135], v2, s[32:35], s57 offen
    v_mfma_f32_32x32x16_bf16 v[40:55], v[136:139], v[124:127], v[40:55]
    v_mfma_f32_32x32x16_bf16 v[56:71], v[136:139], v[128:131], v[56:71]
    s_add_u32 s62, s57, 32768
    buffer_load_dwordx4 v[136:139], v2, s[32:35], s62 offen
    v_mfma_f32_32x32x16_bf16 v[72:87], v[140:143], v[124:127], v[72:87]
    buffer_load_dwordx4 v[124:127], v2, s[32:35], s56 offen sc1
    v_mfma_f32_32x32x16_bf16 v[88:103], v[140:143], v[128:131], v[88:103]
    s_add_u32 s62, s57, 65536
    buffer_load_dwordx4 v[140:143], v2, s[32:35], s62 offen
    s_add_u32 s62, s56, s53
    buffer_load_dwordx4 v[128:131], v2, s[32:35], s62 offen sc1
    s_setprio 3
    s_add_u32 s56, s56, 1024
    s_add_u32 s57, s57, 1024
    s_waitcnt vmcnt(10)
    s_setprio 0
    v_mfma_f32_32x32x16_bf16 v[8:23], v[152:155], v[144:147], v[8:23]
    v_mfma_f32_32x32x16_bf16 v[24:39], v[152:155], v[148:151], v[24:39]
    buffer_load_dwordx4 v[152:155], v2, s[32:35], s57 offen
    v_mfma_f32_32x32x16_bf16 v[40:55], v[156:159], v[144:147], v[40:55]
    v_mfma_f32_32x32x16_bf16 v[56:71], v[156:159], v[148:151], v[56:71]
    s_add_u32 s62, s57, 32768
    buffer_load_dwordx4 v[156:159], v2, s[32:35], s62 offen
    v_mfma_f32_32x32x16_bf16 v[72:87], v[160:163], v[144:147], v[72:87]
    buffer_load_dwordx4 v[144:147], v2, s[32:35], s56 offen sc1
    v_mfma_f32_32x32x16_bf16 v[88:103], v[160:163], v[148:151], v[88:103]
    s_add_u32 s62, s57, 65536
    buffer_load_dwordx4 v[160:163], v2, s[32:35], s62 offen
    s_add_u32 s62, s56, s53
    buffer_load_dwordx4 v[148:151], v2, s[32:35], s62 offen sc1
    s_setprio 3
    s_add_u32 s56, s56, 1024
    s_add_u32 s57, s57, 1024
    s_waitcnt vmcnt(10)
    s_setprio 0
    v_mfma_f32_32x32x16_bf16 v[8:23], v[112:115], v[104:107], v[8:23]
    v_mfma_f32_32x32x16_bf16 v[24:39], v[112:115], v[108:111], v[24:39]
    buffer_load_dwordx4 v[112:115], v2, s[32:35], s57 offen
    v_mfma_f32_32x32x16_bf16 v[40:55], v[116:119], v[104:107], v[40:55]
    v_mfma_f32_32x32x16_bf16 v[56:71], v[116:119], v[108:111], v[56:71]
    s_add_u32 s62, s57, 32768
    buffer_load_dwordx4 v[116:119], v2, s[32:35], s62 offen
    v_mfma_f32_32x32x16_bf16 v[72:87], v[120:123], v[104:107], v[72:87]
    buffer_load_dwordx4 v[104:107], v2, s[32:35], s56 offen sc1
    v_mfma_f32_32x32x16_bf16 v[88:103], v[120:123], v[108:111], v[88:103]
    s_add_u32 s62, s57, 65536
    buffer_load_dwordx4 v[120:123], v2, s[32:35], s62 offen
    s_add_u32 s62, s56, s53
    buffer_load_dwordx4 v[108:111], v2, s[32:35], s62 offen sc1
    s_setprio 3
    s_add_u32 s56, s56, 1024
    s_add_u32 s57, s57, 1024
    s_sub_u32 s58, s58, 1
    s_cmp_lg_u32 s58, 0
    s_cbranch_scc1 L_k2_w3_loop
    s_waitcnt vmcnt(10)
    s_setprio 0
    v_mfma_f32_32x32x16_bf16 v[8:23], v[132:135], v[124:127], v[8:23]
    v_mfma_f32_32x32x16_bf16 v[24:39], v[132:135], v[128:131], v[24:39]
    v_mfma_f32_32x32x16_bf16 v[40:55], v[136:139], v[124:127], v[40:55]
    v_mfma_f32_32x32x16_bf16 v[56:71], v[136:139], v[128:131], v[56:71]
    v_mfma_f32_32x32x16_bf16 v[72:87], v[140:143], v[124:127], v[72:87]
    v_mfma_f32_32x32x16_bf16 v[88:103], v[140:143], v[128:131], v[88:103]
    s_setprio 3
    s_waitcnt vmcnt(5)
    s_setprio 0
    v_mfma_f32_32x32x16_bf16 v[8:23], v[152:155], v[144:147], v[8:23]
    v_mfma_f32_32x32x16_bf16 v[24:39], v[152:155], v[148:151], v[24:39]
    v_mfma_f32_32x32x16_bf16 v[40:55], v[156:159], v[144:147], v[40:55]
    v_mfma_f32_32x32x16_bf16 v[56:71], v[156:159], v[148:151], v[56:71]
    v_mfma_f32_32x32x16_bf16 v[72:87], v[160:163], v[144:147], v[72:87]
    v_mfma_f32_32x32x16_bf16 v[88:103], v[160:163], v[148:151], v[88:103]
    s_setprio 3
    s_waitcnt vmcnt(0)
    s_setprio 0
    v_mfma_f32_32x32x16_bf16 v[8:23], v[112:115], v[104:107], v[8:23]
    v_mfma_f32_32x32x16_bf16 v[24:39], v[112:115], v[108:111], v[24:39]
    v_mfma_f32_32x32x16_bf16 v[40:55], v[116:119], v[104:107], v[40:55]
    v_mfma_f32_32x32x16_bf16 v[56:71], v[116:119], v[108:111], v[56:71]
    v_mfma_f32_32x32x16_bf16 v[72:87], v[120:123], v[104:107], v[72:87]
    v_mfma_f32_32x32x16_bf16 v[88:103], v[120:123], v[108:111], v[88:103]
    s_setprio 3
    v_and_b32 v164, 31, v1
    v_lshrrev_b32 v165, 5, v1
    v_lshlrev_b32 v166, 3, v164
    v_lshl_add_u32 v166, v165, 11, v166
    s_lshl_b32 s60, s64, 12
    s_add_u32 s60, s60, 23592960
    buffer_load_dwordx2 v[144:145], v166, s[32:35], s60 offen offset:0 sc1
    buffer_load_dwordx2 v[146:147], v166, s[32:35], s60 offen offset:256 sc1
    buffer_load_dwordx2 v[148:149], v166, s[32:35], s60 offen offset:512 sc1
    buffer_load_dwordx2 v[150:151], v166, s[32:35], s60 offen offset:768 sc1
    buffer_load_dwordx2 v[152:153], v166, s[32:35], s60 offen offset:1024 sc1
    buffer_load_dwordx2 v[154:155], v166, s[32:35], s60 offen offset:1280 sc1
    buffer_load_dwordx2 v[156:157], v166, s[32:35], s60 offen offset:1536 sc1
    buffer_load_dwordx2 v[158:159], v166, s[32:35], s60 offen offset:1792 sc1
    v_add_u32 v167, s52, v2
    s_nop 3
    ds_write_b128 v3, v[24:27] offset:0
    ds_write_b128 v3, v[28:31] offset:1024
    ds_write_b128 v3, v[32:35] offset:2048
    ds_write_b128 v3, v[36:39] offset:3072
    ds_write_b128 v3, v[56:59] offset:4096
    ds_write_b128 v3, v[60:63] offset:5120
    s_waitcnt lgkmcnt(0)
    v_mov_b32 v6, 162080
    v_mov_b32 v7, 1
    s_mov_b64 exec, 1
    ds_add_u32 v6, v7
    s_mov_b64 exec, -1
    s_waitcnt vmcnt(0)
    v_add_f32 v144, v144, v146
    v_add_f32 v145, v145, v147
    v_add_f32 v144, v144, v148
    v_add_f32 v145, v145, v149
    v_add_f32 v144, v144, v150
    v_add_f32 v145, v145, v151
    v_add_f32 v144, v144, v152
    v_add_f32 v145, v145, v153
    v_add_f32 v144, v144, v154
    v_add_f32 v145, v145, v155
    v_add_f32 v144, v144, v156
    v_add_f32 v145, v145, v157
    v_add_f32 v144, v144, v158
    v_add_f32 v145, v145, v159
    v_mov_b32 v146, v144
    v_mov_b32 v147, v145
    s_mul_i32 s60, s51, 384
    s_add_u32 s60, s60, 161280
    v_permlane32_swap_b32 v144, v146
    v_permlane32_swap_b32 v145, v147
    v_lshl_add_u32 v166, v165, 4, s60
    v_add_f32 v144, v144, v146
    v_add_f32 v145, v145, v147
    v_mul_f32 v148, 0xbb000000, v144
    v_mul_f32 v145, 0x3b000000, v145
    v_fma_f32 v145, -v148, v148, v145
    v_max_f32 v145, 0, v145
    v_add_f32 v145, 0x3727c5ac, v145
    v_rsq_f32 v144, v145
    s_mul_i32 s62, s64, 86
    v_mul_f32 v151, v145, v144
    v_mul_f32 v149, 0xc0135761, v144
    v_mul_f32 v150, v144, v144
    v_mul_f32 v150, v150, v144
    v_mul_f32 v150, 0xbdd2d3e8, v150
    s_lshl_b32 s63, s67, 1
    s_add_u32 s62, s62, s63
    s_lshl_b32 s62, s62, 10
    s_add_u32 s62, s62, 12582912
    s_cmp_ge_u32 s41, 3
    s_cselect_b32 s63, s51, 0
    v_mov_b32 v6, 162080
    s_mov_b32 s68, 20000
L_k2_lwsy4:
    ds_read_b32 v7, v6
    s_waitcnt lgkmcnt(0)
    v_readfirstlane_b32 s69, v7
    s_cmp_ge_u32 s69, 16
    s_cbranch_scc1 L_k2_lwsy4_go
    s_sleep 1
    s_sub_u32 s68, s68, 1
    s_cmp_lg_u32 s68, 0
    s_cbranch_scc1 L_k2_lwsy4
L_k2_lwsy4_go:
    ds_read_b128 v[104:107], v167 offset:0
    ds_read_b128 v[108:111], v167 offset:1024
    ds_read_b128 v[112:115], v167 offset:2048
    ds_read_b128 v[116:119], v167 offset:3072
    ds_read_b128 v[120:123], v167 offset:4096
    ds_read_b128 v[124:127], v167 offset:5120
    s_waitcnt lgkmcnt(0)
    v_mov_b32 v6, 162080
    v_mov_b32 v7, 1
    s_mov_b64 exec, 1
    ds_add_u32 v6, v7
    s_mov_b64 exec, -1
    v_add_f32 v8, v8, v104
    v_add_f32 v9, v9, v105
    v_add_f32 v10, v10, v106
    v_add_f32 v11, v11, v107
    v_add_f32 v12, v12, v108
    v_add_f32 v13, v13, v109
    v_add_f32 v14, v14, v110
    v_add_f32 v15, v15, v111
    v_add_f32 v16, v16, v112
    v_add_f32 v17, v17, v113
    v_add_f32 v18, v18, v114
    v_add_f32 v19, v19, v115
    v_add_f32 v20, v20, v116
    v_add_f32 v21, v21, v117
    v_add_f32 v22, v22, v118
    v_add_f32 v23, v23, v119
    v_add_f32 v40, v40, v120
    v_add_f32 v41, v41, v121
    v_add_f32 v42, v42, v122
    v_add_f32 v43, v43, v123
    v_add_f32 v44, v44, v124
    v_add_f32 v45, v45, v125
    v_add_f32 v46, v46, v126
    v_add_f32 v47, v47, v127
    v_mov_b32 v6, 162080
    s_mov_b32 s68, 20000
L_k2_lwsy5:
    ds_read_b32 v7, v6
    s_waitcnt lgkmcnt(0)
    v_readfirstlane_b32 s69, v7
    s_cmp_ge_u32 s69, 20
    s_cbranch_scc1 L_k2_lwsy5_go
    s_sleep 1
    s_sub_u32 s68, s68, 1
    s_cmp_lg_u32 s68, 0
    s_cbranch_scc1 L_k2_lwsy5
L_k2_lwsy5_go:
    ds_write_b128 v3, v[64:67] offset:0
    ds_write_b128 v3, v[68:71] offset:1024
    ds_write_b128 v3, v[88:91] offset:2048
    ds_write_b128 v3, v[92:95] offset:3072
    ds_write_b128 v3, v[96:99] offset:4096
    ds_write_b128 v3, v[100:103] offset:5120
    s_waitcnt lgkmcnt(0)
    v_mov_b32 v6, 162080
    v_mov_b32 v7, 1
    s_mov_b64 exec, 1
    ds_add_u32 v6, v7
    s_mov_b64 exec, -1
    ds_read_b128 v[128:131], v166 offset:0
    ds_read_b128 v[132:135], v166 offset:32
    ds_read_b128 v[136:139], v166 offset:64
    ds_read_b128 v[140:143], v166 offset:96
    s_waitcnt lgkmcnt(0)
    v_fmac_f32 v8, v148, v128
    v_fmac_f32 v9, v148, v129
    v_fmac_f32 v10, v148, v130
    v_fmac_f32 v11, v148, v131
    v_fmac_f32 v12, v148, v132
    v_fmac_f32 v13, v148, v133
    v_fmac_f32 v14, v148, v134
    v_fmac_f32 v15, v148, v135
    v_fmac_f32 v16, v148, v136
    v_fmac_f32 v17, v148, v137
    v_fmac_f32 v18, v148, v138
    v_fmac_f32 v19, v148, v139
    v_fmac_f32 v20, v148, v140
    v_fmac_f32 v21, v148, v141
    v_fmac_f32 v22, v148, v142
    v_fmac_f32 v23, v148, v143
    v_mul_f32 v24, v8, v8
    v_mul_f32 v25, v9, v9
    v_mul_f32 v26, v10, v10
    v_mul_f32 v27, v11, v11
    v_mul_f32 v28, v12, v12
    v_mul_f32 v29, v13, v13
    v_mul_f32 v30, v14, v14
    v_mul_f32 v31, v15, v15
    v_mul_f32 v32, v16, v16
    v_mul_f32 v33, v17, v17
    v_mul_f32 v34, v18, v18
    v_mul_f32 v35, v19, v19
    v_mul_f32 v36, v20, v20
    v_mul_f32 v37, v21, v21
    v_mul_f32 v38, v22, v22
    v_mul_f32 v39, v23, v23
    v_fma_f32 v24, v24, v150, v149
    v_fma_f32 v25, v25, v150, v149
    v_fma_f32 v26, v26, v150, v149
    v_fma_f32 v27, v27, v150, v149
    v_fma_f32 v28, v28, v150, v149
    v_fma_f32 v29, v29, v150, v149
    v_fma_f32 v30, v30, v150, v149
    v_fma_f32 v31, v31, v150, v149
    v_fma_f32 v32, v32, v150, v149
    v_fma_f32 v33, v33, v150, v149
    v_fma_f32 v34, v34, v150, v149
    v_fma_f32 v35, v35, v150, v149
    v_fma_f32 v36, v36, v150, v149
    v_fma_f32 v37, v37, v150, v149
    v_fma_f32 v38, v38, v150, v149
    v_fma_f32 v39, v39, v150, v149
    v_mul_f32 v24, v24, v8
    v_mul_f32 v25, v25, v9
    v_mul_f32 v26, v26, v10
    v_mul_f32 v27, v27, v11
    v_mul_f32 v28, v28, v12
    v_mul_f32 v29, v29, v13
    v_mul_f32 v30, v30, v14
    v_mul_f32 v31, v31, v15
    v_mul_f32 v32, v32, v16
    v_mul_f32 v33, v33, v17
    v_mul_f32 v34, v34, v18
    v_mul_f32 v35, v35, v19
    v_mul_f32 v36, v36, v20
    v_mul_f32 v37, v37, v21
    v_mul_f32 v38, v38, v22
    v_mul_f32 v39, v39, v23
    v_exp_f32 v24, v24
    v_exp_f32 v25, v25
    v_exp_f32 v26, v26
    v_exp_f32 v27, v27
    v_exp_f32 v28, v28
    v_exp_f32 v29, v29
    v_exp_f32 v30, v30
    v_exp_f32 v31, v31
    v_exp_f32 v32, v32
    v_exp_f32 v33, v33
    v_exp_f32 v34, v34
    v_exp_f32 v35, v35
    v_exp_f32 v36, v36
    v_exp_f32 v37, v37
    v_exp_f32 v38, v38
    v_exp_f32 v39, v39
    v_fma_f32 v24, v24, v151, v151
    v_fma_f32 v25, v25, v151, v151
    v_fma_f32 v26, v26, v151, v151
    v_fma_f32 v27, v27, v151, v151
    v_fma_f32 v28, v28, v151, v151
    v_fma_f32 v29, v29, v151, v151
    v_fma_f32 v30, v30, v151, v151
    v_fma_f32 v31, v31, v151, v151
    v_fma_f32 v32, v32, v151, v151
    v_fma_f32 v33, v33, v151, v151
    v_fma_f32 v34, v34, v151, v151
    v_fma_f32 v35, v35, v151, v151
    v_fma_f32 v36, v36, v151, v151
    v_fma_f32 v37, v37, v151, v151
    v_fma_f32 v38, v38, v151, v151
    v_fma_f32 v39, v39, v151, v151
    v_rcp_f32 v24, v24
    v_rcp_f32 v25, v25
    v_rcp_f32 v26, v26
    v_rcp_f32 v27, v27
    v_rcp_f32 v28, v28
    v_rcp_f32 v29, v29
    v_rcp_f32 v30, v30
    v_rcp_f32 v31, v31
    v_rcp_f32 v32, v32
    v_rcp_f32 v33, v33
    v_rcp_f32 v34, v34
    v_rcp_f32 v35, v35
    v_rcp_f32 v36, v36
    v_rcp_f32 v37, v37
    v_rcp_f32 v38, v38
    v_rcp_f32 v39, v39
    v_mul_f32 v8, v8, v24
    v_mul_f32 v9, v9, v25
    v_mul_f32 v10, v10, v26
    v_mul_f32 v11, v11, v27
    v_mul_f32 v12, v12, v28
    v_mul_f32 v13, v13, v29
    v_mul_f32 v14, v14, v30
    v_mul_f32 v15, v15, v31
    v_mul_f32 v16, v16, v32
    v_mul_f32 v17, v17, v33
    v_mul_f32 v18, v18, v34
    v_mul_f32 v19, v19, v35
    v_mul_f32 v20, v20, v36
    v_mul_f32 v21, v21, v37
    v_mul_f32 v22, v22, v38
    v_mul_f32 v23, v23, v39
    v_cvt_pk_bf16_f32 v24, v8, v9
    v_cvt_pk_bf16_f32 v25, v10, v11
    v_cvt_pk_bf16_f32 v26, v12, v13
    v_cvt_pk_bf16_f32 v27, v14, v15
    v_cvt_pk_bf16_f32 v28, v16, v17
    v_cvt_pk_bf16_f32 v29, v18, v19
    v_cvt_pk_bf16_f32 v30, v20, v21
    v_cvt_pk_bf16_f32 v31, v22, v23
    buffer_store_dwordx4 v[24:27], v2, s[32:35], s62 offen offset:0 sc1
    buffer_store_dwordx4 v[28:31], v2, s[32:35], s62 offen offset:1024 sc1
    v_mov_b32 v6, 162080
    s_mov_b32 s68, 20000
L_k2_lwsy6:
    ds_read_b32 v7, v6
    s_waitcnt lgkmcnt(0)
    v_readfirstlane_b32 s69, v7
    s_cmp_ge_u32 s69, 24
    s_cbranch_scc1 L_k2_lwsy6_go
    s_sleep 1
    s_sub_u32 s68, s68, 1
    s_cmp_lg_u32 s68, 0
    s_cbranch_scc1 L_k2_lwsy6
L_k2_lwsy6_go:
    ds_read_b128 v[104:107], v167 offset:0
    ds_read_b128 v[108:111], v167 offset:1024
    ds_read_b128 v[112:115], v167 offset:2048
    ds_read_b128 v[116:119], v167 offset:3072
    ds_read_b128 v[120:123], v167 offset:4096
    ds_read_b128 v[124:127], v167 offset:5120
    s_waitcnt lgkmcnt(0)
    v_mov_b32 v6, 162104
    v_mov_b32 v7, 1
    s_mov_b64 exec, 1
    ds_add_u32 v6, v7
    s_mov_b64 exec, -1
    v_add_f32 v48, v48, v104
    v_add_f32 v49, v49, v105
    v_add_f32 v50, v50, v106
    v_add_f32 v51, v51, v107
    v_add_f32 v52, v52, v108
    v_add_f32 v53, v53, v109
    v_add_f32 v54, v54, v110
    v_add_f32 v55, v55, v111
    v_add_f32 v72, v72, v112
    v_add_f32 v73, v73, v113
    v_add_f32 v74, v74, v114
    v_add_f32 v75, v75, v115
    v_add_f32 v76, v76, v116
    v_add_f32 v77, v77, v117
    v_add_f32 v78, v78, v118
    v_add_f32 v79, v79, v119
    v_add_f32 v80, v80, v120
    v_add_f32 v81, v81, v121
    v_add_f32 v82, v82, v122
    v_add_f32 v83, v83, v123
    v_add_f32 v84, v84, v124
    v_add_f32 v85, v85, v125
    v_add_f32 v86, v86, v126
    v_add_f32 v87, v87, v127
    ds_read_b128 v[128:131], v166 offset:128
    ds_read_b128 v[132:135], v166 offset:160
    ds_read_b128 v[136:139], v166 offset:192
    ds_read_b128 v[140:143], v166 offset:224
    s_waitcnt lgkmcnt(0)
    v_fmac_f32 v40, v148, v128
    v_fmac_f32 v41, v148, v129
    v_fmac_f32 v42, v148, v130
    v_fmac_f32 v43, v148, v131
    v_fmac_f32 v44, v148, v132
    v_fmac_f32 v45, v148, v133
    v_fmac_f32 v46, v148, v134
    v_fmac_f32 v47, v148, v135
    v_fmac_f32 v48, v148, v136
    v_fmac_f32 v49, v148, v137
    v_fmac_f32 v50, v148, v138
    v_fmac_f32 v51, v148, v139
    v_fmac_f32 v52, v148, v140
    v_fmac_f32 v53, v148, v141
    v_fmac_f32 v54, v148, v142
    v_fmac_f32 v55, v148, v143
    v_mul_f32 v56, v40, v40
    v_mul_f32 v57, v41, v41
    v_mul_f32 v58, v42, v42
    v_mul_f32 v59, v43, v43
    v_mul_f32 v60, v44, v44
    v_mul_f32 v61, v45, v45
    v_mul_f32 v62, v46, v46
    v_mul_f32 v63, v47, v47
    v_mul_f32 v64, v48, v48
    v_mul_f32 v65, v49, v49
    v_mul_f32 v66, v50, v50
    v_mul_f32 v67, v51, v51
    v_mul_f32 v68, v52, v52
    v_mul_f32 v69, v53, v53
    v_mul_f32 v70, v54, v54
    v_mul_f32 v71, v55, v55
    v_fma_f32 v56, v56, v150, v149
    v_fma_f32 v57, v57, v150, v149
    v_fma_f32 v58, v58, v150, v149
    v_fma_f32 v59, v59, v150, v149
    v_fma_f32 v60, v60, v150, v149
    v_fma_f32 v61, v61, v150, v149
    v_fma_f32 v62, v62, v150, v149
    v_fma_f32 v63, v63, v150, v149
    v_fma_f32 v64, v64, v150, v149
    v_fma_f32 v65, v65, v150, v149
    v_fma_f32 v66, v66, v150, v149
    v_fma_f32 v67, v67, v150, v149
    v_fma_f32 v68, v68, v150, v149
    v_fma_f32 v69, v69, v150, v149
    v_fma_f32 v70, v70, v150, v149
    v_fma_f32 v71, v71, v150, v149
    v_mul_f32 v56, v56, v40
    v_mul_f32 v57, v57, v41
    v_mul_f32 v58, v58, v42
    v_mul_f32 v59, v59, v43
    v_mul_f32 v60, v60, v44
    v_mul_f32 v61, v61, v45
    v_mul_f32 v62, v62, v46
    v_mul_f32 v63, v63, v47
    v_mul_f32 v64, v64, v48
    v_mul_f32 v65, v65, v49
    v_mul_f32 v66, v66, v50
    v_mul_f32 v67, v67, v51
    v_mul_f32 v68, v68, v52
    v_mul_f32 v69, v69, v53
    v_mul_f32 v70, v70, v54
    v_mul_f32 v71, v71, v55
    v_exp_f32 v56, v56
    v_exp_f32 v57, v57
    v_exp_f32 v58, v58
    v_exp_f32 v59, v59
    v_exp_f32 v60, v60
    v_exp_f32 v61, v61
    v_exp_f32 v62, v62
    v_exp_f32 v63, v63
    v_exp_f32 v64, v64
    v_exp_f32 v65, v65
    v_exp_f32 v66, v66
    v_exp_f32 v67, v67
    v_exp_f32 v68, v68
    v_exp_f32 v69, v69
    v_exp_f32 v70, v70
    v_exp_f32 v71, v71
    v_fma_f32 v56, v56, v151, v151
    v_fma_f32 v57, v57, v151, v151
    v_fma_f32 v58, v58, v151, v151
    v_fma_f32 v59, v59, v151, v151
    v_fma_f32 v60, v60, v151, v151
    v_fma_f32 v61, v61, v151, v151
    v_fma_f32 v62, v62, v151, v151
    v_fma_f32 v63, v63, v151, v151
    v_fma_f32 v64, v64, v151, v151
    v_fma_f32 v65, v65, v151, v151
    v_fma_f32 v66, v66, v151, v151
    v_fma_f32 v67, v67, v151, v151
    v_fma_f32 v68, v68, v151, v151
    v_fma_f32 v69, v69, v151, v151
    v_fma_f32 v70, v70, v151, v151
    v_fma_f32 v71, v71, v151, v151
    v_rcp_f32 v56, v56
    v_rcp_f32 v57, v57
    v_rcp_f32 v58, v58
    v_rcp_f32 v59, v59
    v_rcp_f32 v60, v60
    v_rcp_f32 v61, v61
    v_rcp_f32 v62, v62
    v_rcp_f32 v63, v63
    v_rcp_f32 v64, v64
    v_rcp_f32 v65, v65
    v_rcp_f32 v66, v66
    v_rcp_f32 v67, v67
    v_rcp_f32 v68, v68
    v_rcp_f32 v69, v69
    v_rcp_f32 v70, v70
    v_rcp_f32 v71, v71
    v_mul_f32 v40, v40, v56
    v_mul_f32 v41, v41, v57
    v_mul_f32 v42, v42, v58
    v_mul_f32 v43, v43, v59
    v_mul_f32 v44, v44, v60
    v_mul_f32 v45, v45, v61
    v_mul_f32 v46, v46, v62
    v_mul_f32 v47, v47, v63
    v_mul_f32 v48, v48, v64
    v_mul_f32 v49, v49, v65
    v_mul_f32 v50, v50, v66
    v_mul_f32 v51, v51, v67
    v_mul_f32 v52, v52, v68
    v_mul_f32 v53, v53, v69
    v_mul_f32 v54, v54, v70
    v_mul_f32 v55, v55, v71
    v_cvt_pk_bf16_f32 v56, v40, v41
    v_cvt_pk_bf16_f32 v57, v42, v43
    v_cvt_pk_bf16_f32 v58, v44, v45
    v_cvt_pk_bf16_f32 v59, v46, v47
    v_cvt_pk_bf16_f32 v60, v48, v49
    v_cvt_pk_bf16_f32 v61, v50, v51
    v_cvt_pk_bf16_f32 v62, v52, v53
    v_cvt_pk_bf16_f32 v63, v54, v55
    buffer_store_dwordx4 v[56:59], v2, s[32:35], s62 offen offset:2048 sc1
    buffer_store_dwordx4 v[60:63], v2, s[32:35], s62 offen offset:3072 sc1
    s_add_u32 s62, s62, 4096
    s_cmp_eq_u32 s63, 1
    s_cbranch_scc1 L_k2_w3_done
    ds_read_b128 v[128:131], v166 offset:256
    ds_read_b128 v[132:135], v166 offset:288
    ds_read_b128 v[136:139], v166 offset:320
    ds_read_b128 v[140:143], v166 offset:352
    s_waitcnt lgkmcnt(0)
    v_fmac_f32 v72, v148, v128
    v_fmac_f32 v73, v148, v129
    v_fmac_f32 v74, v148, v130
    v_fmac_f32 v75, v148, v131
    v_fmac_f32 v76, v148, v132
    v_fmac_f32 v77, v148, v133
    v_fmac_f32 v78, v148, v134
    v_fmac_f32 v79, v148, v135
    v_fmac_f32 v80, v148, v136
    v_fmac_f32 v81, v148, v137
    v_fmac_f32 v82, v148, v138
    v_fmac_f32 v83, v148, v139
    v_fmac_f32 v84, v148, v140
    v_fmac_f32 v85, v148, v141
    v_fmac_f32 v86, v148, v142
    v_fmac_f32 v87, v148, v143
    v_mul_f32 v88, v72, v72
    v_mul_f32 v89, v73, v73
    v_mul_f32 v90, v74, v74
    v_mul_f32 v91, v75, v75
    v_mul_f32 v92, v76, v76
    v_mul_f32 v93, v77, v77
    v_mul_f32 v94, v78, v78
    v_mul_f32 v95, v79, v79
    v_mul_f32 v96, v80, v80
    v_mul_f32 v97, v81, v81
    v_mul_f32 v98, v82, v82
    v_mul_f32 v99, v83, v83
    v_mul_f32 v100, v84, v84
    v_mul_f32 v101, v85, v85
    v_mul_f32 v102, v86, v86
    v_mul_f32 v103, v87, v87
    v_fma_f32 v88, v88, v150, v149
    v_fma_f32 v89, v89, v150, v149
    v_fma_f32 v90, v90, v150, v149
    v_fma_f32 v91, v91, v150, v149
    v_fma_f32 v92, v92, v150, v149
    v_fma_f32 v93, v93, v150, v149
    v_fma_f32 v94, v94, v150, v149
    v_fma_f32 v95, v95, v150, v149
    v_fma_f32 v96, v96, v150, v149
    v_fma_f32 v97, v97, v150, v149
    v_fma_f32 v98, v98, v150, v149
    v_fma_f32 v99, v99, v150, v149
    v_fma_f32 v100, v100, v150, v149
    v_fma_f32 v101, v101, v150, v149
    v_fma_f32 v102, v102, v150, v149
    v_fma_f32 v103, v103, v150, v149
    v_mul_f32 v88, v88, v72
    v_mul_f32 v89, v89, v73
    v_mul_f32 v90, v90, v74
    v_mul_f32 v91, v91, v75
    v_mul_f32 v92, v92, v76
    v_mul_f32 v93, v93, v77
    v_mul_f32 v94, v94, v78
    v_mul_f32 v95, v95, v79
    v_mul_f32 v96, v96, v80
    v_mul_f32 v97, v97, v81
    v_mul_f32 v98, v98, v82
    v_mul_f32 v99, v99, v83
    v_mul_f32 v100, v100, v84
    v_mul_f32 v101, v101, v85
    v_mul_f32 v102, v102, v86
    v_mul_f32 v103, v103, v87
    v_exp_f32 v88, v88
    v_exp_f32 v89, v89
    v_exp_f32 v90, v90
    v_exp_f32 v91, v91
    v_exp_f32 v92, v92
    v_exp_f32 v93, v93
    v_exp_f32 v94, v94
    v_exp_f32 v95, v95
    v_exp_f32 v96, v96
    v_exp_f32 v97, v97
    v_exp_f32 v98, v98
    v_exp_f32 v99, v99
    v_exp_f32 v100, v100
    v_exp_f32 v101, v101
    v_exp_f32 v102, v102
    v_exp_f32 v103, v103
    v_fma_f32 v88, v88, v151, v151
    v_fma_f32 v89, v89, v151, v151
    v_fma_f32 v90, v90, v151, v151
    v_fma_f32 v91, v91, v151, v151
    v_fma_f32 v92, v92, v151, v151
    v_fma_f32 v93, v93, v151, v151
    v_fma_f32 v94, v94, v151, v151
    v_fma_f32 v95, v95, v151, v151
    v_fma_f32 v96, v96, v151, v151
    v_fma_f32 v97, v97, v151, v151
    v_fma_f32 v98, v98, v151, v151
    v_fma_f32 v99, v99, v151, v151
    v_fma_f32 v100, v100, v151, v151
    v_fma_f32 v101, v101, v151, v151
    v_fma_f32 v102, v102, v151, v151
    v_fma_f32 v103, v103, v151, v151
    v_rcp_f32 v88, v88
    v_rcp_f32 v89, v89
    v_rcp_f32 v90, v90
    v_rcp_f32 v91, v91
    v_rcp_f32 v92, v92
    v_rcp_f32 v93, v93
    v_rcp_f32 v94, v94
    v_rcp_f32 v95, v95
    v_rcp_f32 v96, v96
    v_rcp_f32 v97, v97
    v_rcp_f32 v98, v98
    v_rcp_f32 v99, v99
    v_rcp_f32 v100, v100
    v_rcp_f32 v101, v101
    v_rcp_f32 v102, v102
    v_rcp_f32 v103, v103
    v_mul_f32 v72, v72, v88
    v_mul_f32 v73, v73, v89
    v_mul_f32 v74, v74, v90
    v_mul_f32 v75, v75, v91
    v_mul_f32 v76, v76, v92
    v_mul_f32 v77, v77, v93
    v_mul_f32 v78, v78, v94
    v_mul_f32 v79, v79, v95
    v_mul_f32 v80, v80, v96
    v_mul_f32 v81, v81, v97
    v_mul_f32 v82, v82, v98
    v_mul_f32 v83, v83, v99
    v_mul_f32 v84, v84, v100
    v_mul_f32 v85, v85, v101
    v_mul_f32 v86, v86, v102
    v_mul_f32 v87, v87, v103
    v_cvt_pk_bf16_f32 v88, v72, v73
    v_cvt_pk_bf16_f32 v89, v74, v75
    v_cvt_pk_bf16_f32 v90, v76, v77
    v_cvt_pk_bf16_f32 v91, v78, v79
    v_cvt_pk_bf16_f32 v92, v80, v81
    v_cvt_pk_bf16_f32 v93, v82, v83
    v_cvt_pk_bf16_f32 v94, v84, v85
    v_cvt_pk_bf16_f32 v95, v86, v87
    buffer_store_dwordx4 v[88:91], v2, s[32:35], s62 offen offset:0 sc1
    buffer_store_dwordx4 v[92:95], v2, s[32:35], s62 offen offset:1024 sc1
L_k2_w3_done:
    s_waitcnt vmcnt(0)
    s_lshl_b32 s70, s40, 8
    s_add_u32 s70, s70, 29360256
    s_lshl_b32 s61, s41, 2
    s_add_u32 s61, s61, s45
    s_lshl_b32 s61, s61, 2
    v_mov_b32 v6, s61
    v_mov_b32 v7, 1
    s_mov_b64 exec, 1
    buffer_store_dword v7, v6, s[32:35], s70 offen sc1
    s_mov_b64 exec, -1
    v_and_b32 v6, 31, v1
    v_lshlrev_b32 v6, 2, v6
    s_mov_b32 s68, 20000
L_k2_xs1:
    buffer_load_dword v7, v6, s[32:35], s70 offen sc1
    s_waitcnt vmcnt(0)
    v_cmp_eq_u32 vcc, 0, v7
    s_cmp_eq_u64 vcc, 0
    s_cbranch_scc1 L_k2_xs1_go
    s_sleep 2
    s_sub_u32 s68, s68, 1
    s_cmp_lg_u32 s68, 0
    s_cbranch_scc1 L_k2_xs1
L_k2_xs1_go:
    s_lshl_b32 s60, s64, 15
    s_lshl_b32 s61, s65, 6
    s_add_u32 s60, s60, s61
    v_and_b32 v3, 31, v1
    v_lshrrev_b32 v4, 5, v1
    v_lshlrev_b32 v5, 10, v3
    v_lshl_add_u32 v5, v4, 3, v5
    buffer_load_dwordx2 v[152:153], v5, s[24:27], s60 offen offset:0
    buffer_load_dwordx2 v[154:155], v5, s[24:27], s60 offen offset:16
    buffer_load_dwordx2 v[156:157], v5, s[24:27], s60 offen offset:32
    buffer_load_dwordx2 v[158:159], v5, s[24:27], s60 offen offset:48
    s_lshl_b32 s60, s64, 5
    s_lshl_b32 s61, s65, 1
    s_add_u32 s60, s60, s61
    s_lshl_b32 s60, s60, 10
    s_add_u32 s60, s60, 10485760
    buffer_load_dwordx4 v[160:163], v2, s[32:35], s60 offen sc1
    buffer_load_dwordx4 v[164:167], v2, s[32:35], s60 offen offset:1024 sc1
    s_mul_i32 s60, s45, 22
    s_sub_u32 s55, 86, s60
    s_min_u32 s55, s55, 22
    s_mul_i32 s56, s64, 86
    s_add_u32 s56, s56, s60
    s_lshl_b32 s56, s56, 10
    s_add_u32 s56, s56, 12582912
    s_mul_i32 s57, s65, 86
    s_add_u32 s57, s57, s60
    s_lshl_b32 s57, s57, 10
    s_add_u32 s57, s57, 21495808
    s_mov_b32 s53, 88064
    s_cmp_eq_u32 s50, 1
    s_cselect_b32 s53, 4294879232, s53
    s_mov_b32 s54, 88064
    s_cmp_eq_u32 s51, 1
    s_cselect_b32 s54, 4294879232, s54
    s_mov_b32 s59, 2146435072
    s_cmp_gt_i32 s55, 0
    s_cselect_b32 s60, s56, s59
    s_cselect_b32 s61, s57, s59
    s_sub_i32 s55, s55, 1
    buffer_load_dwordx4 v[72:75], v2, s[32:35], s60 offen sc1
    s_add_u32 s62, s60, s53
    buffer_load_dwordx4 v[76:79], v2, s[32:35], s62 offen sc1
    buffer_load_dwordx4 v[80:83], v2, s[32:35], s61 offen
    s_add_u32 s62, s61, s54
    buffer_load_dwordx4 v[84:87], v2, s[32:35], s62 offen
    s_add_u32 s56, s56, 1024
    s_add_u32 s57, s57, 1024
    s_cmp_gt_i32 s55, 0
    s_cselect_b32 s60, s56, s59
    s_cselect_b32 s61, s57, s59
    s_sub_i32 s55, s55, 1
    buffer_load_dwordx4 v[88:91], v2, s[32:35], s60 offen sc1
    s_add_u32 s62, s60, s53
    buffer_load_dwordx4 v[92:95], v2, s[32:35], s62 offen sc1
    buffer_load_dwordx4 v[96:99], v2, s[32:35], s61 offen
    s_add_u32 s62, s61, s54
    buffer_load_dwordx4 v[100:103], v2, s[32:35], s62 offen
    s_add_u32 s56, s56, 1024
    s_add_u32 s57, s57, 1024
    s_cmp_gt_i32 s55, 0
    s_cselect_b32 s60, s56, s59
    s_cselect_b32 s61, s57, s59
    s_sub_i32 s55, s55, 1
    buffer_load_dwordx4 v[104:107], v2, s[32:35], s60 offen sc1
    s_add_u32 s62, s60, s53
    buffer_load_dwordx4 v[108:111], v2, s[32:35], s62 offen sc1
    buffer_load_dwordx4 v[112:115], v2, s[32:35], s61 offen
    s_add_u32 s62, s61, s54
    buffer_load_dwordx4 v[116:119], v2, s[32:35], s62 offen
    s_add_u32 s56, s56, 1024
    s_add_u32 s57, s57, 1024
    s_cmp_gt_i32 s55, 0
    s_cselect_b32 s60, s56, s59
    s_cselect_b32 s61, s57, s59
    s_sub_i32 s55, s55, 1
    buffer_load_dwordx4 v[120:123], v2, s[32:35], s60 offen sc1
    s_add_u32 s62, s60, s53
    buffer_load_dwordx4 v[124:127], v2, s[32:35], s62 offen sc1
    buffer_load_dwordx4 v[128:131], v2, s[32:35], s61 offen
    s_add_u32 s62, s61, s54
    buffer_load_dwordx4 v[132:135], v2, s[32:35], s62 offen
    s_add_u32 s56, s56, 1024
    s_add_u32 s57, s57, 1024
    s_cmp_gt_i32 s55, 0
    s_cselect_b32 s60, s56, s59
    s_cselect_b32 s61, s57, s59
    s_sub_i32 s55, s55, 1
    buffer_load_dwordx4 v[136:139], v2, s[32:35], s60 offen sc1
    s_add_u32 s62, s60, s53
    buffer_load_dwordx4 v[140:143], v2, s[32:35], s62 offen sc1
    buffer_load_dwordx4 v[144:147], v2, s[32:35], s61 offen
    s_add_u32 s62, s61, s54
    buffer_load_dwordx4 v[148:151], v2, s[32:35], s62 offen
    s_add_u32 s56, s56, 1024
    s_add_u32 s57, s57, 1024
    s_waitcnt vmcnt(16)
    s_cmp_gt_i32 s55, 0
    s_cselect_b32 s60, s56, s59
    s_cselect_b32 s61, s57, s59
    s_sub_i32 s55, s55, 1
    s_setprio 0
    v_mfma_f32_32x32x16_bf16 v[8:23], v[80:83], v[72:75], 0
    v_mfma_f32_32x32x16_bf16 v[24:39], v[80:83], v[76:79], 0
    buffer_load_dwordx4 v[80:83], v2, s[32:35], s61 offen
    v_mfma_f32_32x32x16_bf16 v[40:55], v[84:87], v[72:75], 0
    buffer_load_dwordx4 v[72:75], v2, s[32:35], s60 offen sc1
    v_mfma_f32_32x32x16_bf16 v[56:71], v[84:87], v[76:79], 0
    s_add_u32 s62, s61, s54
    buffer_load_dwordx4 v[84:87], v2, s[32:35], s62 offen
    s_add_u32 s62, s60, s53
    buffer_load_dwordx4 v[76:79], v2, s[32:35], s62 offen sc1
    s_setprio 3
    s_add_u32 s56, s56, 1024
    s_add_u32 s57, s57, 1024
    s_mov_b32 s58, 3
L_k2_w4_loop:
    s_waitcnt vmcnt(16)
    s_cmp_gt_i32 s55, 0
    s_cselect_b32 s60, s56, s59
    s_cselect_b32 s61, s57, s59
    s_sub_i32 s55, s55, 1
    s_setprio 0
    v_mfma_f32_32x32x16_bf16 v[8:23], v[96:99], v[88:91], v[8:23]
    v_mfma_f32_32x32x16_bf16 v[24:39], v[96:99], v[92:95], v[24:39]
    buffer_load_dwordx4 v[96:99], v2, s[32:35], s61 offen
    v_mfma_f32_32x32x16_bf16 v[40:55], v[100:103], v[88:91], v[40:55]
    buffer_load_dwordx4 v[88:91], v2, s[32:35], s60 offen sc1
    v_mfma_f32_32x32x16_bf16 v[56:71], v[100:103], v[92:95], v[56:71]
    s_add_u32 s62, s61, s54
    buffer_load_dwordx4 v[100:103], v2, s[32:35], s62 offen
    s_add_u32 s62, s60, s53
    buffer_load_dwordx4 v[92:95], v2, s[32:35], s62 offen sc1
    s_setprio 3
    s_add_u32 s56, s56, 1024
    s_add_u32 s57, s57, 1024
    s_waitcnt vmcnt(16)
    s_cmp_gt_i32 s55, 0
    s_cselect_b32 s60, s56, s59
    s_cselect_b32 s61, s57, s59
    s_sub_i32 s55, s55, 1
    s_setprio 0
    v_mfma_f32_32x32x16_bf16 v[8:23], v[112:115], v[104:107], v[8:23]
    v_mfma_f32_32x32x16_bf16 v[24:39], v[112:115], v[108:111], v[24:39]
    buffer_load_dwordx4 v[112:115], v2, s[32:35], s61 offen
    v_mfma_f32_32x32x16_bf16 v[40:55], v[116:119], v[104:107], v[40:55]
    buffer_load_dwordx4 v[104:107], v2, s[32:35], s60 offen sc1
    v_mfma_f32_32x32x16_bf16 v[56:71], v[116:119], v[108:111], v[56:71]
    s_add_u32 s62, s61, s54
    buffer_load_dwordx4 v[116:119], v2, s[32:35], s62 offen
    s_add_u32 s62, s60, s53
    buffer_load_dwordx4 v[108:111], v2, s[32:35], s62 offen sc1
    s_setprio 3
    s_add_u32 s56, s56, 1024
    s_add_u32 s57, s57, 1024
    s_waitcnt vmcnt(16)
    s_cmp_gt_i32 s55, 0
    s_cselect_b32 s60, s56, s59
    s_cselect_b32 s61, s57, s59
    s_sub_i32 s55, s55, 1
    s_setprio 0
    v_mfma_f32_32x32x16_bf16 v[8:23], v[128:131], v[120:123], v[8:23]
    v_mfma_f32_32x32x16_bf16 v[24:39], v[128:131], v[124:127], v[24:39]
    buffer_load_dwordx4 v[128:131], v2, s[32:35], s61 offen
    v_mfma_f32_32x32x16_bf16 v[40:55], v[132:135], v[120:123], v[40:55]
    buffer_load_dwordx4 v[120:123], v2, s[32:35], s60 offen sc1
    v_mfma_f32_32x32x16_bf16 v[56:71], v[132:135], v[124:127], v[56:71]
    s_add_u32 s62, s61, s54
    buffer_load_dwordx4 v[132:135], v2, s[32:35], s62 offen
    s_add_u32 s62, s60, s53
    buffer_load_dwordx4 v[124:127], v2, s[32:35], s62 offen sc1
    s_setprio 3
    s_add_u32 s56, s56, 1024
    s_add_u32 s57, s57, 1024
    s_waitcnt vmcnt(16)
    s_cmp_gt_i32 s55, 0
    s_cselect_b32 s60, s56, s59
    s_cselect_b32 s61, s57, s59
    s_sub_i32 s55, s55, 1
    s_setprio 0
    v_mfma_f32_32x32x16_bf16 v[8:23], v[144:147], v[136:139], v[8:23]
    v_mfma_f32_32x32x16_bf16 v[24:39], v[144:147], v[140:143], v[24:39]
    buffer_load_dwordx4 v[144:147], v2, s[32:35], s61 offen
    v_mfma_f32_32x32x16_bf16 v[40:55], v[148:151], v[136:139], v[40:55]
    buffer_load_dwordx4 v[136:139], v2, s[32:35], s60 offen sc1
    v_mfma_f32_32x32x16_bf16 v[56:71], v[148:151], v[140:143], v[56:71]
    s_add_u32 s62, s61, s54
    buffer_load_dwordx4 v[148:151], v2, s[32:35], s62 offen
    s_add_u32 s62, s60, s53
    buffer_load_dwordx4 v[140:143], v2, s[32:35], s62 offen sc1
    s_setprio 3
    s_add_u32 s56, s56, 1024
    s_add_u32 s57, s57, 1024
    s_waitcnt vmcnt(16)
    s_cmp_gt_i32 s55, 0
    s_cselect_b32 s60, s56, s59
    s_cselect_b32 s61, s57, s59
    s_sub_i32 s55, s55, 1
    s_setprio 0
    v_mfma_f32_32x32x16_bf16 v[8:23], v[80:83], v[72:75], v[8:23]
    v_mfma_f32_32x32x16_bf16 v[24:39], v[80:83], v[76:79], v[24:39]
    buffer_load_dwordx4 v[80:83], v2, s[32:35], s61 offen
    v_mfma_f32_32x32x16_bf16 v[40:55], v[84:87], v[72:75], v[40:55]
    buffer_load_dwordx4 v[72:75], v2, s[32:35], s60 offen sc1
    v_mfma_f32_32x32x16_bf16 v[56:71], v[84:87], v[76:79], v[56:71]
    s_add_u32 s62, s61, s54
    buffer_load_dwordx4 v[84:87], v2, s[32:35], s62 offen
    s_add_u32 s62, s60, s53
    buffer_load_dwordx4 v[76:79], v2, s[32:35], s62 offen sc1
    s_setprio 3
    s_add_u32 s56, s56, 1024
    s_add_u32 s57, s57, 1024
    s_sub_u32 s58, s58, 1
    s_cmp_lg_u32 s58, 0
    s_cbranch_scc1 L_k2_w4_loop
    s_waitcnt vmcnt(16)
    s_cmp_gt_i32 s55, 0
    s_cselect_b32 s60, s56, s59
    s_cselect_b32 s61, s57, s59
    s_sub_i32 s55, s55, 1
    s_setprio 0
    v_mfma_f32_32x32x16_bf16 v[8:23], v[96:99], v[88:91], v[8:23]
    v_mfma_f32_32x32x16_bf16 v[24:39], v[96:99], v[92:95], v[24:39]
    buffer_load_dwordx4 v[96:99], v2, s[32:35], s61 offen
    v_mfma_f32_32x32x16_bf16 v[40:55], v[100:103], v[88:91], v[40:55]
    buffer_load_dwordx4 v[88:91], v2, s[32:35], s60 offen sc1
    v_mfma_f32_32x32x16_bf16 v[56:71], v[100:103], v[92:95], v[56:71]
    s_add_u32 s62, s61, s54
    buffer_load_dwordx4 v[100:103], v2, s[32:35], s62 offen
    s_add_u32 s62, s60, s53
    buffer_load_dwordx4 v[92:95], v2, s[32:35], s62 offen sc1
    s_setprio 3
    s_add_u32 s56, s56, 1024
    s_add_u32 s57, s57, 1024
    s_waitcnt vmcnt(16)
    s_setprio 0
    v_mfma_f32_32x32x16_bf16 v[8:23], v[112:115], v[104:107], v[8:23]
    v_mfma_f32_32x32x16_bf16 v[24:39], v[112:115], v[108:111], v[24:39]
    v_mfma_f32_32x32x16_bf16 v[40:55], v[116:119], v[104:107], v[40:55]
    v_mfma_f32_32x32x16_bf16 v[56:71], v[116:119], v[108:111], v[56:71]
    s_setprio 3
    s_waitcnt vmcnt(12)
    s_setprio 0
    v_mfma_f32_32x32x16_bf16 v[8:23], v[128:131], v[120:123], v[8:23]
    v_mfma_f32_32x32x16_bf16 v[24:39], v[128:131], v[124:127], v[24:39]
    v_mfma_f32_32x32x16_bf16 v[40:55], v[132:135], v[120:123], v[40:55]
    v_mfma_f32_32x32x16_bf16 v[56:71], v[132:135], v[124:127], v[56:71]
    s_setprio 3
    s_waitcnt vmcnt(8)
    s_setprio 0
    v_mfma_f32_32x32x16_bf16 v[8:23], v[144:147], v[136:139], v[8:23]
    v_mfma_f32_32x32x16_bf16 v[24:39], v[144:147], v[140:143], v[24:39]
    v_mfma_f32_32x32x16_bf16 v[40:55], v[148:151], v[136:139], v[40:55]
    v_mfma_f32_32x32x16_bf16 v[56:71], v[148:151], v[140:143], v[56:71]
    s_setprio 3
    s_waitcnt vmcnt(4)
    s_setprio 0
    v_mfma_f32_32x32x16_bf16 v[8:23], v[80:83], v[72:75], v[8:23]
    v_mfma_f32_32x32x16_bf16 v[24:39], v[80:83], v[76:79], v[24:39]
    v_mfma_f32_32x32x16_bf16 v[40:55], v[84:87], v[72:75], v[40:55]
    v_mfma_f32_32x32x16_bf16 v[56:71], v[84:87], v[76:79], v[56:71]
    s_setprio 3
    s_waitcnt vmcnt(0)
    s_setprio 0
    v_mfma_f32_32x32x16_bf16 v[8:23], v[96:99], v[88:91], v[8:23]
    v_mfma_f32_32x32x16_bf16 v[24:39], v[96:99], v[92:95], v[24:39]
    v_mfma_f32_32x32x16_bf16 v[40:55], v[100:103], v[88:91], v[40:55]
    v_mfma_f32_32x32x16_bf16 v[56:71], v[100:103], v[92:95], v[56:71]
    s_setprio 3
    s_setprio 0
    s_nop 7
    s_nop 3
    s_mov_b32 s60, 0xffff0000
    v_lshlrev_b32 v72, 16, v152
    v_and_b32 v73, s60, v152
    v_lshlrev_b32 v74, 16, v153
    v_and_b32 v75, s60, v153
    v_lshlrev_b32 v76, 16, v154
    v_and_b32 v77, s60, v154
    v_lshlrev_b32 v78, 16, v155
    v_and_b32 v79, s60, v155
    v_lshlrev_b32 v80, 16, v156
    v_and_b32 v81, s60, v156
    v_lshlrev_b32 v82, 16, v157
    v_and_b32 v83, s60, v157
    v_lshlrev_b32 v84, 16, v158
    v_and_b32 v85, s60, v158
    v_lshlrev_b32 v86, 16, v159
    v_and_b32 v87, s60, v159
    v_add_f32 v8, v8, v72
    v_add_f32 v9, v9, v73
    v_add_f32 v10, v10, v74
    v_add_f32 v11, v11, v75
    v_add_f32 v12, v12, v76
    v_add_f32 v13, v13, v77
    v_add_f32 v14, v14, v78
    v_add_f32 v15, v15, v79
    v_add_f32 v16, v16, v80
    v_add_f32 v17, v17, v81
    v_add_f32 v18, v18, v82
    v_add_f32 v19, v19, v83
    v_add_f32 v20, v20, v84
    v_add_f32 v21, v21, v85
    v_add_f32 v22, v22, v86
    v_add_f32 v23, v23, v87
    v_lshlrev_b32 v72, 16, v160
    v_and_b32 v73, s60, v160
    v_lshlrev_b32 v74, 16, v161
    v_and_b32 v75, s60, v161
    v_lshlrev_b32 v76, 16, v162
    v_and_b32 v77, s60, v162
    v_lshlrev_b32 v78, 16, v163
    v_and_b32 v79, s60, v163
    v_lshlrev_b32 v80, 16, v164
    v_and_b32 v81, s60, v164
    v_lshlrev_b32 v82, 16, v165
    v_and_b32 v83, s60, v165
    v_lshlrev_b32 v84, 16, v166
    v_and_b32 v85, s60, v166
    v_lshlrev_b32 v86, 16, v167
    v_and_b32 v87, s60, v167
    v_add_f32 v8, v8, v72
    v_add_f32 v9, v9, v73
    v_add_f32 v10, v10, v74
    v_add_f32 v11, v11, v75
    v_add_f32 v12, v12, v76
    v_add_f32 v13, v13, v77
    v_add_f32 v14, v14, v78
    v_add_f32 v15, v15, v79
    v_add_f32 v16, v16, v80
    v_add_f32 v17, v17, v81
    v_add_f32 v18, v18, v82
    v_add_f32 v19, v19, v83
    v_add_f32 v20, v20, v84
    v_add_f32 v21, v21, v85
    v_add_f32 v22, v22, v86
    v_add_f32 v23, v23, v87
    s_lshl_b32 s60, s45, 3
    s_lshl_b32 s56, s64, 5
    s_add_u32 s56, s56, s60
    s_lshl_b32 s56, s56, 10
    s_add_u32 s56, s56, 8388608
    s_lshl_b32 s57, s65, 5
    s_add_u32 s57, s57, s60
    s_lshl_b32 s57, s57, 10
    s_add_u32 s57, s57, 19398656
    s_mov_b32 s53, 32768
    s_cmp_eq_u32 s50, 1
    s_cselect_b32 s53, 4294934528, s53
    s_mov_b32 s54, 32768
    s_cmp_eq_u32 s51, 1
    s_cselect_b32 s54, 4294934528, s54
    s_add_u32 s53, s53, s56
    s_add_u32 s54, s54, s57
    buffer_load_dwordx4 v[136:139], v2, s[32:35], s57 offen offset:0
    buffer_load_dwordx4 v[140:143], v2, s[32:35], s54 offen offset:0
    buffer_load_dwordx4 v[144:147], v2, s[32:35], s57 offen offset:1024
    buffer_load_dwordx4 v[148:151], v2, s[32:35], s54 offen offset:1024
    buffer_load_dwordx4 v[152:155], v2, s[32:35], s57 offen offset:2048
    buffer_load_dwordx4 v[156:159], v2, s[32:35], s54 offen offset:2048
    buffer_load_dwordx4 v[160:163], v2, s[32:35], s57 offen offset:3072
    buffer_load_dwordx4 v[164:167], v2, s[32:35], s54 offen offset:3072
    s_add_u32 s57, s57, 4096
    s_add_u32 s54, s54, 4096
    s_lshl_b32 s70, s40, 8
    s_lshl_b32 s60, s45, 5
    s_add_u32 s70, s70, s60
    s_add_u32 s70, s70, 29368320
    v_and_b32 v6, 7, v1
    v_lshlrev_b32 v6, 2, v6
    v_bfe_u32 v7, v1, 3, 1
    v_lshl_add_u32 v6, v7, 7, v6
    s_mov_b32 s68, 20000
    s_setprio 0
L_k2_ow:
    buffer_load_dword v7, v6, s[32:35], s70 offen sc1
    s_waitcnt vmcnt(0)
    v_cmp_eq_u32 vcc, 0, v7
    s_cmp_eq_u64 vcc, 0
    s_cbranch_scc1 L_k2_ow_go
    s_sleep 2
    s_sub_u32 s68, s68, 1
    s_cmp_lg_u32 s68, 0
    s_cbranch_scc1 L_k2_ow
L_k2_ow_go:
    s_setprio 3
    buffer_load_dwordx4 v[72:75], v2, s[32:35], s56 offen offset:0 sc1
    buffer_load_dwordx4 v[76:79], v2, s[32:35], s53 offen offset:0 sc1
    buffer_load_dwordx4 v[80:83], v2, s[32:35], s56 offen offset:1024 sc1
    buffer_load_dwordx4 v[84:87], v2, s[32:35], s53 offen offset:1024 sc1
    buffer_load_dwordx4 v[88:91], v2, s[32:35], s56 offen offset:2048 sc1
    buffer_load_dwordx4 v[92:95], v2, s[32:35], s53 offen offset:2048 sc1
    buffer_load_dwordx4 v[96:99], v2, s[32:35], s56 offen offset:3072 sc1
    buffer_load_dwordx4 v[100:103], v2, s[32:35], s53 offen offset:3072 sc1
    s_add_u32 s56, s56, 4096
    s_add_u32 s53, s53, 4096
    buffer_load_dwordx4 v[104:107], v2, s[32:35], s56 offen offset:0 sc1
    buffer_load_dwordx4 v[108:111], v2, s[32:35], s53 offen offset:0 sc1
    buffer_load_dwordx4 v[112:115], v2, s[32:35], s56 offen offset:1024 sc1
    buffer_load_dwordx4 v[116:119], v2, s[32:35], s53 offen offset:1024 sc1
    buffer_load_dwordx4 v[120:123], v2, s[32:35], s56 offen offset:2048 sc1
    buffer_load_dwordx4 v[124:127], v2, s[32:35], s53 offen offset:2048 sc1
    buffer_load_dwordx4 v[128:131], v2, s[32:35], s56 offen offset:3072 sc1
    buffer_load_dwordx4 v[132:135], v2, s[32:35], s53 offen offset:3072 sc1
    v_mov_b32 v6, 162100
    s_mov_b32 s68, 20000
L_k2_lwad:
    ds_read_b32 v7, v6
    s_waitcnt lgkmcnt(0)
    v_readfirstlane_b32 s69, v7
    s_cmp_ge_u32 s69, 8
    s_cbranch_scc1 L_k2_lwad_go
    s_sleep 1
    s_sub_u32 s68, s68, 1
    s_cmp_lg_u32 s68, 0
    s_cbranch_scc1 L_k2_lwad
L_k2_lwad_go:
    s_xor_b32 s60, s45, 1
    s_mul_i32 s60, s60, 12288
    s_add_u32 s60, s60, 0
    v_add_u32 v3, s60, v2
    s_xor_b32 s60, s45, 2
    s_mul_i32 s60, s60, 12288
    s_add_u32 s60, s60, 4096
    v_add_u32 v4, s60, v2
    s_xor_b32 s60, s45, 3
    s_mul_i32 s60, s60, 12288
    s_add_u32 s60, s60, 8192
    v_add_u32 v5, s60, v2
    s_waitcnt vmcnt(14)
    v_mfma_f32_32x32x16_bf16 v[8:23], v[136:139], v[72:75], v[8:23]
    v_mfma_f32_32x32x16_bf16 v[24:39], v[136:139], v[76:79], v[24:39]
    v_mfma_f32_32x32x16_bf16 v[40:55], v[140:143], v[72:75], v[40:55]
    v_mfma_f32_32x32x16_bf16 v[56:71], v[140:143], v[76:79], v[56:71]
    buffer_load_dwordx4 v[136:139], v2, s[32:35], s57 offen offset:0
    buffer_load_dwordx4 v[140:143], v2, s[32:35], s54 offen offset:0
    s_waitcnt vmcnt(14)
    v_mfma_f32_32x32x16_bf16 v[8:23], v[144:147], v[80:83], v[8:23]
    v_mfma_f32_32x32x16_bf16 v[24:39], v[144:147], v[84:87], v[24:39]
    v_mfma_f32_32x32x16_bf16 v[40:55], v[148:151], v[80:83], v[40:55]
    v_mfma_f32_32x32x16_bf16 v[56:71], v[148:151], v[84:87], v[56:71]
    buffer_load_dwordx4 v[144:147], v2, s[32:35], s57 offen offset:1024
    buffer_load_dwordx4 v[148:151], v2, s[32:35], s54 offen offset:1024
    s_waitcnt vmcnt(14)
    v_mfma_f32_32x32x16_bf16 v[8:23], v[152:155], v[88:91], v[8:23]
    v_mfma_f32_32x32x16_bf16 v[24:39], v[152:155], v[92:95], v[24:39]
    v_mfma_f32_32x32x16_bf16 v[40:55], v[156:159], v[88:91], v[40:55]
    v_mfma_f32_32x32x16_bf16 v[56:71], v[156:159], v[92:95], v[56:71]
    buffer_load_dwordx4 v[152:155], v2, s[32:35], s57 offen offset:2048
    buffer_load_dwordx4 v[156:159], v2, s[32:35], s54 offen offset:2048
    s_waitcnt vmcnt(14)
    v_mfma_f32_32x32x16_bf16 v[8:23], v[160:163], v[96:99], v[8:23]
    v_mfma_f32_32x32x16_bf16 v[24:39], v[160:163], v[100:103], v[24:39]
    v_mfma_f32_32x32x16_bf16 v[40:55], v[164:167], v[96:99], v[40:55]
    v_mfma_f32_32x32x16_bf16 v[56:71], v[164:167], v[100:103], v[56:71]
    buffer_load_dwordx4 v[160:163], v2, s[32:35], s57 offen offset:3072
    buffer_load_dwordx4 v[164:167], v2, s[32:35], s54 offen offset:3072
    s_waitcnt vmcnt(6)
    v_mfma_f32_32x32x16_bf16 v[8:23], v[136:139], v[104:107], v[8:23]
    v_mfma_f32_32x32x16_bf16 v[24:39], v[136:139], v[108:111], v[24:39]
    v_mfma_f32_32x32x16_bf16 v[40:55], v[140:143], v[104:107], v[40:55]
    v_mfma_f32_32x32x16_bf16 v[56:71], v[140:143], v[108:111], v[56:71]
    s_waitcnt vmcnt(4)
    v_mfma_f32_32x32x16_bf16 v[8:23], v[144:147], v[112:115], v[8:23]
    v_mfma_f32_32x32x16_bf16 v[24:39], v[144:147], v[116:119], v[24:39]
    v_mfma_f32_32x32x16_bf16 v[40:55], v[148:151], v[112:115], v[40:55]
    v_mfma_f32_32x32x16_bf16 v[56:71], v[148:151], v[116:119], v[56:71]
    s_waitcnt vmcnt(2)
    v_mfma_f32_32x32x16_bf16 v[8:23], v[152:155], v[120:123], v[8:23]
    v_mfma_f32_32x32x16_bf16 v[24:39], v[152:155], v[124:127], v[24:39]
    v_mfma_f32_32x32x16_bf16 v[40:55], v[156:159], v[120:123], v[40:55]
    v_mfma_f32_32x32x16_bf16 v[56:71], v[156:159], v[124:127], v[56:71]
    s_waitcnt vmcnt(0)
    v_mfma_f32_32x32x16_bf16 v[8:23], v[160:163], v[128:131], v[8:23]
    v_mfma_f32_32x32x16_bf16 v[24:39], v[160:163], v[132:135], v[24:39]
    v_mfma_f32_32x32x16_bf16 v[40:55], v[164:167], v[128:131], v[40:55]
    v_mfma_f32_32x32x16_bf16 v[56:71], v[164:167], v[132:135], v[56:71]
    s_mul_i32 s60, s45, 12288
    v_add_u32 v136, s60, v2
    v_and_b32 v152, 31, v1
    v_lshrrev_b32 v153, 5, v1
    v_lshlrev_b32 v154, 10, v152
    v_lshl_add_u32 v154, v153, 4, v154
    s_nop 7
    ds_write_b128 v3, v[24:27] offset:0
    ds_write_b128 v3, v[28:31] offset:1024
    ds_write_b128 v3, v[32:35] offset:2048
    ds_write_b128 v3, v[36:39] offset:3072
    ds_write_b128 v4, v[40:43] offset:0
    ds_write_b128 v4, v[44:47] offset:1024
    ds_write_b128 v4, v[48:51] offset:2048
    ds_write_b128 v4, v[52:55] offset:3072
    ds_write_b128 v5, v[56:59] offset:0
    ds_write_b128 v5, v[60:63] offset:1024
    ds_write_b128 v5, v[64:67] offset:2048
    ds_write_b128 v5, v[68:71] offset:3072
    s_waitcnt lgkmcnt(0)
    v_mov_b32 v6, 162080
    v_mov_b32 v7, 1
    s_mov_b64 exec, 1
    ds_add_u32 v6, v7
    s_mov_b64 exec, -1
    s_mov_b32 s68, 20000
L_k2_lwsy7:
    ds_read_b32 v7, v6
    s_waitcnt lgkmcnt(0)
    v_readfirstlane_b32 s69, v7
    s_cmp_ge_u32 s69, 28
    s_cbranch_scc1 L_k2_lwsy7_go
    s_sleep 1
    s_sub_u32 s68, s68, 1
    s_cmp_lg_u32 s68, 0
    s_cbranch_scc1 L_k2_lwsy7
L_k2_lwsy7_go:
    ds_read_b128 v[72:75], v136 offset:0
    ds_read_b128 v[76:79], v136 offset:1024
    ds_read_b128 v[80:83], v136 offset:2048
    ds_read_b128 v[84:87], v136 offset:3072
    ds_read_b128 v[88:91], v136 offset:4096
    ds_read_b128 v[92:95], v136 offset:5120
    ds_read_b128 v[96:99], v136 offset:6144
    ds_read_b128 v[100:103], v136 offset:7168
    ds_read_b128 v[104:107], v136 offset:8192
    ds_read_b128 v[108:111], v136 offset:9216
    ds_read_b128 v[112:115], v136 offset:10240
    ds_read_b128 v[116:119], v136 offset:11264
    s_waitcnt lgkmcnt(8)
    v_add_f32 v8, v8, v72
    v_add_f32 v9, v9, v73
    v_add_f32 v10, v10, v74
    v_add_f32 v11, v11, v75
    v_add_f32 v12, v12, v76
    v_add_f32 v13, v13, v77
    v_add_f32 v14, v14, v78
    v_add_f32 v15, v15, v79
    v_add_f32 v16, v16, v80
    v_add_f32 v17, v17, v81
    v_add_f32 v18, v18, v82
    v_add_f32 v19, v19, v83
    v_add_f32 v20, v20, v84
    v_add_f32 v21, v21, v85
    v_add_f32 v22, v22, v86
    v_add_f32 v23, v23, v87
    s_waitcnt lgkmcnt(4)
    v_add_f32 v8, v8, v88
    v_add_f32 v9, v9, v89
    v_add_f32 v10, v10, v90
    v_add_f32 v11, v11, v91
    v_add_f32 v12, v12, v92
    v_add_f32 v13, v13, v93
    v_add_f32 v14, v14, v94
    v_add_f32 v15, v15, v95
    v_add_f32 v16, v16, v96
    v_add_f32 v17, v17, v97
    v_add_f32 v18, v18, v98
    v_add_f32 v19, v19, v99
    v_add_f32 v20, v20, v100
    v_add_f32 v21, v21, v101
    v_add_f32 v22, v22, v102
    v_add_f32 v23, v23, v103
    s_waitcnt lgkmcnt(0)
    v_add_f32 v8, v8, v104
    v_add_f32 v9, v9, v105
    v_add_f32 v10, v10, v106
    v_add_f32 v11, v11, v107
    v_add_f32 v12, v12, v108
    v_add_f32 v13, v13, v109
    v_add_f32 v14, v14, v110
    v_add_f32 v15, v15, v111
    v_add_f32 v16, v16, v112
    v_add_f32 v17, v17, v113
    v_add_f32 v18, v18, v114
    v_add_f32 v19, v19, v115
    v_add_f32 v20, v20, v116
    v_add_f32 v21, v21, v117
    v_add_f32 v22, v22, v118
    v_add_f32 v23, v23, v119
    v_cvt_pk_bf16_f32 v72, v8, v9
    v_cvt_pk_bf16_f32 v73, v10, v11
    v_cvt_pk_bf16_f32 v74, v12, v13
    v_cvt_pk_bf16_f32 v75, v14, v15
    v_cvt_pk_bf16_f32 v76, v16, v17
    v_cvt_pk_bf16_f32 v77, v18, v19
    v_cvt_pk_bf16_f32 v78, v20, v21
    v_cvt_pk_bf16_f32 v79, v22, v23
    s_lshl_b32 s60, s64, 15
    s_lshl_b32 s61, s65, 6
    v_permlane32_swap_b32 v72, v74
    v_permlane32_swap_b32 v73, v75
    v_permlane32_swap_b32 v76, v78
    v_permlane32_swap_b32 v77, v79
    s_add_u32 s60, s60, s61
    buffer_store_dwordx4 v[72:75], v154, s[28:31], s60 offen
    buffer_store_dwordx4 v[76:79], v154, s[28:31], s60 offen offset:32
L_k2_exit:
    s_endpgm
L_code_end:
.section .rodata,"a"
.p2align 6
.amdhsa_kernel k1_kernel
  .amdhsa_next_free_vgpr 168
  .amdhsa_next_free_sgpr 96
  .amdhsa_accum_offset 168
  .amdhsa_group_segment_fixed_size 0
  .amdhsa_kernarg_size 88
  .amdhsa_user_sgpr_count 2
  .amdhsa_user_sgpr_kernarg_segment_ptr 1
  .amdhsa_system_sgpr_workgroup_id_x 1
.end_amdhsa_kernel
.p2align 6
.amdhsa_kernel k2_kernel
  .amdhsa_next_free_vgpr 168
  .amdhsa_next_free_sgpr 96
  .amdhsa_accum_offset 168
  .amdhsa_group_segment_fixed_size 0
  .amdhsa_kernarg_size 88
  .amdhsa_user_sgpr_count 2
  .amdhsa_user_sgpr_kernarg_segment_ptr 1
  .amdhsa_system_sgpr_workgroup_id_x 1
.end_amdhsa_kernel
```
